```python
import torch

def _softmax(x, axis=-1):
    return torch.softmax(x, dim=axis)
def _gelu(x):
    return torch.nn.functional.gelu(x, approximate="tanh")
def _silu(x):
    return torch.nn.functional.silu(x)
def _sigmoid(x):
    return torch.sigmoid(x)
def _layernorm(x, axis=-1, eps=1e-5):
    m = x.mean(dim=axis, keepdim=True)
    v = x.var(dim=axis, keepdim=True, unbiased=False)
    return (x - m) / torch.sqrt(v + eps)
def _scatter_add(tgt, idx, src, axis=0):
    return tgt.clone().index_add_(axis, idx, src)
def _segment_sum(src, seg, n):
    out = torch.zeros((n,) + src.shape[1:], dtype=src.dtype)
    return out.index_add_(0, seg, src)
def _pad(x, pw):
    flat = tuple(v for pair in reversed(pw) for v in pair)
    return torch.nn.functional.pad(x, flat)

kernel_name = 'interleave_layers__compressed_kv_cla__glu_gated_swiglu__decode'

def setup_inputs():

    _w = (lambda a: (lambda t: t.to(torch.bfloat16) if t.is_floating_point() else t)(torch.as_tensor(a)))
    def _A_setup():
        B, H, Sq, Sk, D, M = 2, 32, 1, 8192, 128, 512
        Dc = 4 * D
        return {
            "x": _w((lambda *s: torch.randn(*s, dtype=torch.bfloat16) * 0.05)(B, Sq, M)),
            "c_kv": _w((lambda *s: torch.randn(*s, dtype=torch.bfloat16) * 0.8)(B, Sk, Dc)),
            "w_q": _w((lambda *s: torch.randn(*s, dtype=torch.bfloat16) * 1.6)(M, H, D) * (M ** -0.5)),
            "w_uk": _w((lambda *s: torch.randn(*s, dtype=torch.bfloat16) * 1.6)(Dc, H, D) * (Dc ** -0.5)),
            "w_uv": _w((lambda *s: torch.randn(*s, dtype=torch.bfloat16) * 0.8)(Dc, H, D) * (Dc ** -0.5)),
            "w_o": _w((lambda *s: torch.randn(*s, dtype=torch.bfloat16) * 0.8)(H, D, M) * ((H * D) ** -0.5)),
        }
    _A_in = _A_setup()

    def _B_setup():
        B, S, D, F = 2, 1, 512, 1792
        return {
            "x": _w((lambda *s: torch.randn(*s, dtype=torch.bfloat16) * 0.05)(B, S, D)),
            "w1": _w((lambda *s: torch.randn(*s, dtype=torch.bfloat16) * 0.4)(D, F) * (2.0 / D) ** 0.5),
            "w3": _w((lambda *s: torch.randn(*s, dtype=torch.bfloat16) * 0.4)(D, F) * (2.0 / D) ** 0.5),
            "w2": _w((lambda *s: torch.randn(*s, dtype=torch.bfloat16) * 0.4)(F, D) * (2.0 / F) ** 0.5),
        }
    _B_in = _B_setup()

    return {
        "A_x": _A_in["x"],
        "A_c_kv": _A_in["c_kv"],
        "A_w_q": _A_in["w_q"],
        "A_w_uk": _A_in["w_uk"],
        "A_w_uv": _A_in["w_uv"],
        "A_w_o": _A_in["w_o"],
        "B_x": _B_in["x"],
        "B_w1": _B_in["w1"],
        "B_w3": _B_in["w3"],
        "B_w2": _B_in["w2"],
    }

def reference(A_x, A_c_kv, A_w_q, A_w_uk, A_w_uv, A_w_o, B_x, B_w1, B_w3, B_w2):
    def _A_ref(x, c_kv, w_q, w_uk, w_uv, w_o):
        B, Sq, M = x.shape[0], x.shape[1], x.shape[2]
        Sk = c_kv.shape[1]
        H, D = w_q.shape[1], w_q.shape[2]
        q = torch.einsum("bqm,mhd->bhqd", x, w_q)
        k = torch.einsum("bkc,chd->bhkd", c_kv, w_uk)
        v = torch.einsum("bkc,chd->bhkd", c_kv, w_uv)
        scores = torch.einsum("bhqd,bhkd->bhqk", q, k) * (D ** -0.5)
        off = Sk - Sq
        qi = torch.arange(Sq)[:, None]
        kj = torch.arange(Sk)[None, :]
        cmask = kj <= (qi + off)
        scores = torch.where(cmask[None, None], scores, -1e9)
        p = _softmax(scores, axis=-1)
        ctx = torch.einsum("bhqk,bhkd->bhqd", p, v)
        return torch.einsum("bhqd,hdm->bqm", ctx, w_o)

    def _B_ref(x, w1, w3, w2):
        gate = torch.einsum("bsd,df->bsf", x, w1)
        up = torch.einsum("bsd,df->bsf", x, w3)
        h = _silu(gate) * up
        out = torch.einsum("bsf,fd->bsd", h, w2)
        return out

    x = A_x
    x = x + _A_ref(_layernorm(x, axis=-1), A_c_kv, A_w_q, A_w_uk, A_w_uv, A_w_o)
    x = x + _B_ref(_layernorm(x, axis=-1), B_w1, B_w3, B_w2)
    x = x + _A_ref(_layernorm(x, axis=-1), A_c_kv, A_w_q, A_w_uk, A_w_uv, A_w_o)
    x = x + _B_ref(_layernorm(x, axis=-1), B_w1, B_w3, B_w2)
    return x
```

```asm
; @launch grid=(256,1,1) block=(256,1,1) lds=163840
.amdgcn_target "amdgcn-amd-amdhsa--gfx950"
.text
.globl interleave_layers__compressed_kv_cla__glu_gated_swiglu__decode_kernel
.p2align 8
.type interleave_layers__compressed_kv_cla__glu_gated_swiglu__decode_kernel,@function
interleave_layers__compressed_kv_cla__glu_gated_swiglu__decode_kernel:
    s_cmp_ge_u32 s2, 256
    s_cbranch_scc1 L_end
    s_load_dwordx2 s[8:9], s[0:1], 0
    s_load_dwordx2 s[12:13], s[0:1], 8
    s_load_dwordx2 s[16:17], s[0:1], 16
    s_load_dwordx2 s[20:21], s[0:1], 24
    s_load_dwordx2 s[24:25], s[0:1], 32
    s_load_dwordx2 s[28:29], s[0:1], 40
    s_load_dwordx2 s[32:33], s[0:1], 56
    s_load_dwordx2 s[36:37], s[0:1], 64
    s_load_dwordx2 s[40:41], s[0:1], 72
    s_load_dwordx2 s[44:45], s[0:1], 80
    s_load_dwordx2 s[48:49], s[0:1], 96
    v_and_b32 v1, 63, v0
    v_lshrrev_b32 v5, 6, v0
    v_lshlrev_b32 v2, 3, v0
    v_readfirstlane_b32 s52, v5
    v_lshlrev_b32 v3, 4, v0
    v_lshlrev_b32 v4, 4, v1
    s_and_b32 s56, s2, 7
    s_bfe_u32 s62, s2, 0x20003
    s_lshl_b32 s62, s62, 3
    s_add_u32 s56, s56, s62
    s_lshr_b32 s57, s2, 5
    s_and_b32 s59, s57, 1
    s_lshr_b32 s58, s57, 1
    s_and_b32 s60, s2, 7
    s_lshr_b32 s62, s2, 5
    s_xor_b32 s62, s62, 4
    s_lshl_b32 s62, s62, 3
    s_add_u32 s60, s60, s62
    s_cmp_lt_u32 s60, 28
    s_cselect_b32 s61, 1, 0
    s_lshl_b32 s60, s60, 2
    s_bfe_u32 s62, s2, 0x20003
    s_add_u32 s60, s60, s62
    s_mov_b32 s54, 0
    s_mov_b32 s55, 0
    s_mov_b32 s10, 0x800
    s_mov_b32 s11, 0x00020000
    s_mov_b32 s14, 0x1000000
    s_mov_b32 s15, 0x00020000
    s_mov_b32 s18, 0x400000
    s_mov_b32 s19, 0x00020000
    s_mov_b32 s22, 0x400000
    s_mov_b32 s23, 0x00020000
    s_mov_b32 s26, 0x400000
    s_mov_b32 s27, 0x00020000
    s_mov_b32 s30, 0x400000
    s_mov_b32 s31, 0x00020000
    s_mov_b32 s34, 0x1c0000
    s_mov_b32 s35, 0x00020000
    s_mov_b32 s38, 0x1c0000
    s_mov_b32 s39, 0x00020000
    s_mov_b32 s42, 0x1c0000
    s_mov_b32 s43, 0x00020000
    s_mov_b32 s46, 0x800
    s_mov_b32 s47, 0x00020000
    s_mov_b32 s50, 0x10000000
    s_mov_b32 s51, 0x00020000
    s_waitcnt lgkmcnt(0)
    v_mov_b32 v5, 0
    s_mov_b32 s62, 0x1100000
    buffer_load_dword v20, v5, s[48:51], s62 offen sc0 sc1
    v_mov_b32 v12, 0
    v_mov_b32 v13, 0
    v_mov_b32 v14, 0
    v_mov_b32 v15, 0
    s_and_b32 s62, s2, 127
    s_mul_i32 s62, s62, 512
    s_lshr_b32 s63, s2, 7
    s_mul_i32 s63, s63, 0x800000
    s_add_u32 s62, s62, s63
    s_add_u32 s62, s62, 0x20000
    v_cmp_gt_u32 vcc, 32, v0
    s_and_saveexec_b64 s[72:73], vcc
    buffer_store_dwordx4 v[12:15], v3, s[48:51], s62 offen sc0 sc1
    s_mov_b64 exec, s[72:73]
    s_waitcnt vmcnt(1)
    v_readfirstlane_b32 s53, v20
    s_add_u32 s53, s53, 1
    s_cmp_lg_u32 s2, 0
    s_cbranch_scc1 L_nz
    v_lshlrev_b32 v16, 8, v0
    s_mov_b32 s62, 0x1200000
    buffer_store_dword v12, v16, s[48:51], s62 offen sc0 sc1
    s_add_u32 s62, s62, 0x10000
    buffer_store_dword v12, v16, s[48:51], s62 offen sc0 sc1
    s_add_u32 s62, s62, 0x10000
    buffer_store_dword v12, v16, s[48:51], s62 offen sc0 sc1
    s_add_u32 s62, s62, 0x10000
    buffer_store_dword v12, v16, s[48:51], s62 offen sc0 sc1
    s_add_u32 s62, s62, 0x10000
    s_waitcnt vmcnt(0)
    s_barrier
    v_mov_b32 v16, 0
    v_mov_b32 v17, s53
    s_mov_b32 s62, 0x1000000
    v_cmp_eq_u32 vcc, 0, v0
    s_and_saveexec_b64 s[72:73], vcc
    buffer_store_dword v17, v16, s[48:51], s62 offen sc0 sc1
    s_mov_b64 exec, s[72:73]
    L_nz:
    s_cmp_ge_u32 s2, 128
    s_cbranch_scc1 L_nflow
    s_mov_b32 s80, s52
    s_lshl_b32 s70, s2, 17
    s_lshl_b32 s71, s80, 15
    s_add_u32 s70, s70, s71
    s_mov_b32 m0, s71
    s_add_u32 s71, s71, 4096
    v_xor_b32 v8, 0, v4
    buffer_load_dwordx4 v8, s[12:15], s70 offen offset:0 lds
    v_xor_b32 v9, 64, v4
    buffer_load_dwordx4 v9, s[12:15], s70 offen offset:1024 lds
    v_xor_b32 v8, 128, v4
    buffer_load_dwordx4 v8, s[12:15], s70 offen offset:2048 lds
    v_xor_b32 v9, 192, v4
    buffer_load_dwordx4 v9, s[12:15], s70 offen offset:3072 lds
    s_mov_b32 m0, s71
    s_add_u32 s70, s70, 4096
    s_add_u32 s71, s71, 4096
    v_xor_b32 v8, 16, v4
    buffer_load_dwordx4 v8, s[12:15], s70 offen offset:0 lds
    v_xor_b32 v9, 80, v4
    buffer_load_dwordx4 v9, s[12:15], s70 offen offset:1024 lds
    v_xor_b32 v8, 144, v4
    buffer_load_dwordx4 v8, s[12:15], s70 offen offset:2048 lds
    v_xor_b32 v9, 208, v4
    buffer_load_dwordx4 v9, s[12:15], s70 offen offset:3072 lds
    s_mov_b32 m0, s71
    s_add_u32 s70, s70, 4096
    s_add_u32 s71, s71, 4096
    v_xor_b32 v8, 32, v4
    buffer_load_dwordx4 v8, s[12:15], s70 offen offset:0 lds
    v_xor_b32 v9, 96, v4
    buffer_load_dwordx4 v9, s[12:15], s70 offen offset:1024 lds
    v_xor_b32 v8, 160, v4
    buffer_load_dwordx4 v8, s[12:15], s70 offen offset:2048 lds
    v_xor_b32 v9, 224, v4
    buffer_load_dwordx4 v9, s[12:15], s70 offen offset:3072 lds
    s_mov_b32 m0, s71
    s_add_u32 s70, s70, 4096
    s_add_u32 s71, s71, 4096
    v_xor_b32 v8, 48, v4
    buffer_load_dwordx4 v8, s[12:15], s70 offen offset:0 lds
    v_xor_b32 v9, 112, v4
    buffer_load_dwordx4 v9, s[12:15], s70 offen offset:1024 lds
    v_xor_b32 v8, 176, v4
    buffer_load_dwordx4 v8, s[12:15], s70 offen offset:2048 lds
    v_xor_b32 v9, 240, v4
    buffer_load_dwordx4 v9, s[12:15], s70 offen offset:3072 lds
    s_mov_b32 m0, s71
    s_add_u32 s70, s70, 4096
    s_add_u32 s71, s71, 4096
    v_xor_b32 v8, 0, v4
    buffer_load_dwordx4 v8, s[12:15], s70 offen offset:0 lds
    v_xor_b32 v9, 64, v4
    buffer_load_dwordx4 v9, s[12:15], s70 offen offset:1024 lds
    v_xor_b32 v8, 128, v4
    buffer_load_dwordx4 v8, s[12:15], s70 offen offset:2048 lds
    v_xor_b32 v9, 192, v4
    buffer_load_dwordx4 v9, s[12:15], s70 offen offset:3072 lds
    s_mov_b32 m0, s71
    s_add_u32 s70, s70, 4096
    s_add_u32 s71, s71, 4096
    v_xor_b32 v8, 16, v4
    buffer_load_dwordx4 v8, s[12:15], s70 offen offset:0 lds
    v_xor_b32 v9, 80, v4
    buffer_load_dwordx4 v9, s[12:15], s70 offen offset:1024 lds
    v_xor_b32 v8, 144, v4
    buffer_load_dwordx4 v8, s[12:15], s70 offen offset:2048 lds
    v_xor_b32 v9, 208, v4
    buffer_load_dwordx4 v9, s[12:15], s70 offen offset:3072 lds
    s_mov_b32 m0, s71
    s_add_u32 s70, s70, 4096
    s_add_u32 s71, s71, 4096
    v_xor_b32 v8, 32, v4
    buffer_load_dwordx4 v8, s[12:15], s70 offen offset:0 lds
    v_xor_b32 v9, 96, v4
    buffer_load_dwordx4 v9, s[12:15], s70 offen offset:1024 lds
    v_xor_b32 v8, 160, v4
    buffer_load_dwordx4 v8, s[12:15], s70 offen offset:2048 lds
    v_xor_b32 v9, 224, v4
    buffer_load_dwordx4 v9, s[12:15], s70 offen offset:3072 lds
    s_mov_b32 m0, s71
    s_add_u32 s70, s70, 4096
    s_add_u32 s71, s71, 4096
    v_xor_b32 v8, 48, v4
    buffer_load_dwordx4 v8, s[12:15], s70 offen offset:0 lds
    v_xor_b32 v9, 112, v4
    buffer_load_dwordx4 v9, s[12:15], s70 offen offset:1024 lds
    v_xor_b32 v8, 176, v4
    buffer_load_dwordx4 v8, s[12:15], s70 offen offset:2048 lds
    v_xor_b32 v9, 240, v4
    buffer_load_dwordx4 v9, s[12:15], s70 offen offset:3072 lds
    v_lshrrev_b32 v5, 2, v1
    v_and_b32 v6, 3, v1
    v_bfe_u32 v7, v5, 3, 1
    v_lshlrev_b32 v7, 1, v7
    v_xor_b32 v6, v6, v7
    v_lshlrev_b32 v6, 4, v6
    v_lshl_add_u32 v8, v5, 13, v6
    v_lshrrev_b32 v5, 3, v1
    v_and_b32 v6, 7, v1
    v_and_b32 v7, 2, v5
    v_xor_b32 v6, v6, v7
    v_lshlrev_b32 v6, 4, v6
    v_lshl_add_u32 v9, v5, 10, v6
    v_xor_b32 v10, 0x40, v9
    s_lshl_b32 s70, s58, 20
    s_lshl_b32 s62, s56, 8
    s_add_u32 s70, s70, s62
    s_lshl_b32 s62, s52, 6
    s_add_u32 s70, s70, s62
    s_lshl_b32 s71, s52, 13
    s_add_u32 s71, s71, 131072
    s_mov_b32 m0, s71
    s_add_u32 s71, s71, 1024
    buffer_load_dwordx4 v8, s[24:27], s70 offen lds
    s_add_u32 s70, s70, 0x20000
    s_mov_b32 m0, s71
    s_add_u32 s71, s71, 1024
    buffer_load_dwordx4 v8, s[24:27], s70 offen lds
    s_add_u32 s70, s70, 0x20000
    s_mov_b32 m0, s71
    s_add_u32 s71, s71, 1024
    buffer_load_dwordx4 v8, s[24:27], s70 offen lds
    s_add_u32 s70, s70, 0x20000
    s_mov_b32 m0, s71
    s_add_u32 s71, s71, 1024
    buffer_load_dwordx4 v8, s[24:27], s70 offen lds
    s_add_u32 s70, s70, 0x20000
    s_mov_b32 m0, s71
    s_add_u32 s71, s71, 1024
    buffer_load_dwordx4 v8, s[24:27], s70 offen lds
    s_add_u32 s70, s70, 0x20000
    s_mov_b32 m0, s71
    s_add_u32 s71, s71, 1024
    buffer_load_dwordx4 v8, s[24:27], s70 offen lds
    s_add_u32 s70, s70, 0x20000
    s_mov_b32 m0, s71
    s_add_u32 s71, s71, 1024
    buffer_load_dwordx4 v8, s[24:27], s70 offen lds
    s_add_u32 s70, s70, 0x20000
    s_mov_b32 m0, s71
    s_nop 0
    buffer_load_dwordx4 v8, s[24:27], s70 offen lds
    s_waitcnt vmcnt(0)
    s_lshl_b32 s64, s52, 13
    s_add_u32 s64, s64, 131072
    v_lshrrev_b32 v5, 4, v1
    v_bfe_u32 v6, v1, 2, 2
    v_lshl_add_u32 v12, v5, 3, v6
    v_lshlrev_b32 v12, 6, v12
    v_and_b32 v5, 1, v5
    v_lshl_add_u32 v12, v5, 5, v12
    v_and_b32 v6, 3, v1
    v_lshl_add_u32 v12, v6, 3, v12
    v_add_u32 v12, s64, v12
    v_xor_b32 v13, 32, v12
    ds_read_b64_tr_b16 a[128:129], v12 offset:0
    ds_read_b64_tr_b16 a[130:131], v12 offset:256
    ds_read_b64_tr_b16 a[132:133], v13 offset:0
    ds_read_b64_tr_b16 a[134:135], v13 offset:256
    ds_read_b64_tr_b16 a[136:137], v12 offset:2048
    ds_read_b64_tr_b16 a[138:139], v12 offset:2304
    ds_read_b64_tr_b16 a[140:141], v13 offset:2048
    ds_read_b64_tr_b16 a[142:143], v13 offset:2304
    ds_read_b64_tr_b16 a[144:145], v12 offset:4096
    ds_read_b64_tr_b16 a[146:147], v12 offset:4352
    ds_read_b64_tr_b16 a[148:149], v13 offset:4096
    ds_read_b64_tr_b16 a[150:151], v13 offset:4352
    s_waitcnt lgkmcnt(10)
    ds_read_b64_tr_b16 a[152:153], v12 offset:6144
    ds_read_b64_tr_b16 a[154:155], v12 offset:6400
    s_waitcnt lgkmcnt(10)
    ds_read_b64_tr_b16 a[156:157], v13 offset:6144
    ds_read_b64_tr_b16 a[158:159], v13 offset:6400
    s_waitcnt lgkmcnt(0)
    s_lshl_b32 s70, s56, 17
    s_lshl_b32 s62, s59, 9
    s_add_u32 s70, s70, s62
    s_lshl_b32 s62, s52, 7
    s_add_u32 s70, s70, s62
    s_add_u32 s70, s70, 0
    s_mul_i32 s71, s52, 8192
    s_add_u32 s71, s71, 131072
    s_mov_b32 m0, s71
    s_add_u32 s71, s71, 1024
    buffer_load_dwordx4 v9, s[28:31], s70 offen lds
    s_add_u32 s70, s70, 0x2000
    s_mov_b32 m0, s71
    s_add_u32 s71, s71, 1024
    buffer_load_dwordx4 v10, s[28:31], s70 offen lds
    s_add_u32 s70, s70, 0x2000
    s_mov_b32 m0, s71
    s_add_u32 s71, s71, 1024
    buffer_load_dwordx4 v9, s[28:31], s70 offen lds
    s_add_u32 s70, s70, 0x2000
    s_mov_b32 m0, s71
    s_add_u32 s71, s71, 1024
    buffer_load_dwordx4 v10, s[28:31], s70 offen lds
    s_add_u32 s70, s70, 0x2000
    s_mov_b32 m0, s71
    s_add_u32 s71, s71, 1024
    buffer_load_dwordx4 v9, s[28:31], s70 offen lds
    s_add_u32 s70, s70, 0x2000
    s_mov_b32 m0, s71
    s_add_u32 s71, s71, 1024
    buffer_load_dwordx4 v10, s[28:31], s70 offen lds
    s_add_u32 s70, s70, 0x2000
    s_mov_b32 m0, s71
    s_add_u32 s71, s71, 1024
    buffer_load_dwordx4 v9, s[28:31], s70 offen lds
    s_add_u32 s70, s70, 0x2000
    s_mov_b32 m0, s71
    s_nop 0
    buffer_load_dwordx4 v10, s[28:31], s70 offen lds
    s_waitcnt vmcnt(0)
    s_mul_i32 s64, s52, 8192
    s_add_u32 s64, s64, 131072
    v_lshrrev_b32 v5, 4, v1
    v_bfe_u32 v6, v1, 2, 2
    v_lshl_add_u32 v12, v5, 3, v6
    v_lshlrev_b32 v12, 7, v12
    v_and_b32 v5, 1, v5
    v_lshrrev_b32 v6, 1, v6
    v_lshl_add_u32 v5, v5, 1, v6
    v_lshl_add_u32 v12, v5, 5, v12
    v_and_b32 v6, 3, v1
    v_lshl_add_u32 v12, v6, 3, v12
    v_add_u32 v12, s64, v12
    v_xor_b32 v13, 32, v12
    v_xor_b32 v14, 64, v12
    v_xor_b32 v15, 96, v12
    ds_read_b64_tr_b16 a[160:161], v12 offset:0
    ds_read_b64_tr_b16 a[162:163], v12 offset:512
    ds_read_b64_tr_b16 a[164:165], v13 offset:0
    ds_read_b64_tr_b16 a[166:167], v13 offset:512
    ds_read_b64_tr_b16 a[168:169], v14 offset:0
    ds_read_b64_tr_b16 a[170:171], v14 offset:512
    ds_read_b64_tr_b16 a[172:173], v15 offset:0
    ds_read_b64_tr_b16 a[174:175], v15 offset:512
    ds_read_b64_tr_b16 a[176:177], v12 offset:4096
    ds_read_b64_tr_b16 a[178:179], v12 offset:4608
    ds_read_b64_tr_b16 a[180:181], v13 offset:4096
    ds_read_b64_tr_b16 a[182:183], v13 offset:4608
    s_waitcnt lgkmcnt(10)
    ds_read_b64_tr_b16 a[184:185], v14 offset:4096
    ds_read_b64_tr_b16 a[186:187], v14 offset:4608
    s_waitcnt lgkmcnt(10)
    ds_read_b64_tr_b16 a[188:189], v15 offset:4096
    ds_read_b64_tr_b16 a[190:191], v15 offset:4608
    s_waitcnt lgkmcnt(0)
    s_lshl_b32 s70, s56, 17
    s_lshl_b32 s62, s59, 9
    s_add_u32 s70, s70, s62
    s_lshl_b32 s62, s52, 7
    s_add_u32 s70, s70, s62
    s_add_u32 s70, s70, 65536
    s_mul_i32 s71, s52, 8192
    s_add_u32 s71, s71, 131072
    s_mov_b32 m0, s71
    s_add_u32 s71, s71, 1024
    buffer_load_dwordx4 v9, s[28:31], s70 offen lds
    s_add_u32 s70, s70, 0x2000
    s_mov_b32 m0, s71
    s_add_u32 s71, s71, 1024
    buffer_load_dwordx4 v10, s[28:31], s70 offen lds
    s_add_u32 s70, s70, 0x2000
    s_mov_b32 m0, s71
    s_add_u32 s71, s71, 1024
    buffer_load_dwordx4 v9, s[28:31], s70 offen lds
    s_add_u32 s70, s70, 0x2000
    s_mov_b32 m0, s71
    s_add_u32 s71, s71, 1024
    buffer_load_dwordx4 v10, s[28:31], s70 offen lds
    s_add_u32 s70, s70, 0x2000
    s_mov_b32 m0, s71
    s_add_u32 s71, s71, 1024
    buffer_load_dwordx4 v9, s[28:31], s70 offen lds
    s_add_u32 s70, s70, 0x2000
    s_mov_b32 m0, s71
    s_add_u32 s71, s71, 1024
    buffer_load_dwordx4 v10, s[28:31], s70 offen lds
    s_add_u32 s70, s70, 0x2000
    s_mov_b32 m0, s71
    s_add_u32 s71, s71, 1024
    buffer_load_dwordx4 v9, s[28:31], s70 offen lds
    s_add_u32 s70, s70, 0x2000
    s_mov_b32 m0, s71
    s_nop 0
    buffer_load_dwordx4 v10, s[28:31], s70 offen lds
    s_waitcnt vmcnt(0)
    s_mul_i32 s64, s52, 8192
    s_add_u32 s64, s64, 131072
    v_lshrrev_b32 v5, 4, v1
    v_bfe_u32 v6, v1, 2, 2
    v_lshl_add_u32 v12, v5, 3, v6
    v_lshlrev_b32 v12, 7, v12
    v_and_b32 v5, 1, v5
    v_lshrrev_b32 v6, 1, v6
    v_lshl_add_u32 v5, v5, 1, v6
    v_lshl_add_u32 v12, v5, 5, v12
    v_and_b32 v6, 3, v1
    v_lshl_add_u32 v12, v6, 3, v12
    v_add_u32 v12, s64, v12
    v_xor_b32 v13, 32, v12
    v_xor_b32 v14, 64, v12
    v_xor_b32 v15, 96, v12
    ds_read_b64_tr_b16 a[192:193], v12 offset:0
    ds_read_b64_tr_b16 a[194:195], v12 offset:512
    ds_read_b64_tr_b16 a[196:197], v13 offset:0
    ds_read_b64_tr_b16 a[198:199], v13 offset:512
    ds_read_b64_tr_b16 a[200:201], v14 offset:0
    ds_read_b64_tr_b16 a[202:203], v14 offset:512
    ds_read_b64_tr_b16 a[204:205], v15 offset:0
    ds_read_b64_tr_b16 a[206:207], v15 offset:512
    ds_read_b64_tr_b16 a[208:209], v12 offset:4096
    ds_read_b64_tr_b16 a[210:211], v12 offset:4608
    ds_read_b64_tr_b16 a[212:213], v13 offset:4096
    ds_read_b64_tr_b16 a[214:215], v13 offset:4608
    s_waitcnt lgkmcnt(10)
    ds_read_b64_tr_b16 a[216:217], v14 offset:4096
    ds_read_b64_tr_b16 a[218:219], v14 offset:4608
    s_waitcnt lgkmcnt(10)
    ds_read_b64_tr_b16 a[220:221], v15 offset:4096
    ds_read_b64_tr_b16 a[222:223], v15 offset:4608
    s_waitcnt lgkmcnt(0)
    s_cmp_lg_u32 s52, 0
    s_cbranch_scc1 L_zc1
    s_mov_b32 s63, 400000
    s_mov_b32 s62, 0x1000000
    v_mov_b32 v5, 0
L_zl2:
    buffer_load_dword v6, v5, s[48:51], s62 offen sc0 sc1
    s_waitcnt vmcnt(0)
    v_cmp_ne_u32 vcc, s53, v6
    s_cbranch_vccz L_zc1
    s_sub_u32 s63, s63, 1
    s_cmp_lg_u32 s63, 0
    s_cbranch_scc1 L_zl2
L_zc1:
L_bloop:
    s_cmp_lg_u32 s52, 0
    s_cbranch_scc1 L_wf3
    s_mov_b32 s63, 400000
    s_sub_u32 s62, s54, 0
    s_lshl_b32 s62, s62, 17
    s_add_u32 s62, s62, 0x1200000
    s_and_b32 s64, s2, 7
    s_lshl_b32 s64, s64, 12
    s_add_u32 s62, s62, s64
    v_and_b32 v5, 15, v1
    v_mov_b32 v6, 8
    v_lshlrev_b32 v5, 8, v5
L_poll4:
    buffer_load_dword v196, v5, s[48:51], s62 offen sc0 sc1
    s_waitcnt vmcnt(0)
    v_cmp_ne_u32 vcc, v6, v196
    s_cbranch_vccz L_pdone5
    s_sub_u32 s63, s63, 1
    s_cmp_lg_u32 s63, 0
    s_cbranch_scc1 L_poll4
L_pdone5:
L_wf3:
    s_barrier
    s_and_b32 s62, s52, 1
    s_lshl_b32 s62, s62, 5
    v_xor_b32 v10, s62, v4
    s_lshr_b32 s63, s2, 6
    s_lshl_b32 s63, s63, 15
    s_lshl_b32 s64, s52, 13
    s_add_u32 s63, s63, s64
    s_add_u32 s63, s63, s55
    s_add_u32 s65, s63, 4096
    v_xor_b32 v8, 0, v10
    buffer_load_dwordx4 v[68:71], v8, s[48:51], s63 offen offset:0 sc0 sc1
    v_xor_b32 v9, 64, v10
    buffer_load_dwordx4 v[72:75], v9, s[48:51], s63 offen offset:1024 sc0 sc1
    v_xor_b32 v8, 128, v10
    buffer_load_dwordx4 v[76:79], v8, s[48:51], s63 offen offset:2048 sc0 sc1
    v_xor_b32 v9, 192, v10
    buffer_load_dwordx4 v[80:83], v9, s[48:51], s63 offen offset:3072 sc0 sc1
    v_xor_b32 v8, 16, v10
    buffer_load_dwordx4 v[84:87], v8, s[48:51], s65 offen offset:0 sc0 sc1
    v_xor_b32 v9, 80, v10
    buffer_load_dwordx4 v[88:91], v9, s[48:51], s65 offen offset:1024 sc0 sc1
    v_xor_b32 v8, 144, v10
    buffer_load_dwordx4 v[92:95], v8, s[48:51], s65 offen offset:2048 sc0 sc1
    v_xor_b32 v9, 208, v10
    buffer_load_dwordx4 v[96:99], v9, s[48:51], s65 offen offset:3072 sc0 sc1
    s_add_u32 s64, s64, 131072
    v_add_u32 v10, s64, v4
    v_and_b32 v8, 31, v1
    v_lshrrev_b32 v9, 5, v1
    v_and_b32 v7, 3, v1
    v_lshlrev_b32 v7, 2, v7
    v_bfe_u32 v12, v1, 2, 2
    v_or_b32 v7, v7, v12
    v_xor_b32 v7, v7, v9
    v_lshlrev_b32 v7, 4, v7
    v_lshl_add_u32 v100, v8, 10, v7
    s_lshl_b32 s62, s52, 15
    v_add_u32 v12, s62, v100
    v_add_u32 v100, 131072, v100
    v_xor_b32 v13, 32, v12
    v_xor_b32 v101, 32, v100
    v_xor_b32 v14, 64, v12
    v_xor_b32 v102, 64, v100
    v_xor_b32 v15, 96, v12
    v_xor_b32 v103, 96, v100
    v_xor_b32 v16, 128, v12
    v_xor_b32 v104, 128, v100
    v_xor_b32 v17, 160, v12
    v_xor_b32 v105, 160, v100
    v_xor_b32 v18, 192, v12
    v_xor_b32 v106, 192, v100
    v_xor_b32 v19, 224, v12
    v_xor_b32 v107, 224, v100
    s_waitcnt vmcnt(7)
    ds_write_b128 v10, v[68:71] offset:0
    s_waitcnt vmcnt(6)
    ds_write_b128 v10, v[72:75] offset:1024
    s_waitcnt vmcnt(5)
    ds_write_b128 v10, v[76:79] offset:2048
    s_waitcnt vmcnt(4)
    ds_write_b128 v10, v[80:83] offset:3072
    s_waitcnt vmcnt(3)
    ds_write_b128 v10, v[84:87] offset:4096
    s_waitcnt vmcnt(2)
    ds_write_b128 v10, v[88:91] offset:5120
    s_waitcnt vmcnt(1)
    ds_write_b128 v10, v[92:95] offset:6144
    s_waitcnt vmcnt(0)
    ds_write_b128 v10, v[96:99] offset:7168
    s_waitcnt lgkmcnt(0)
    s_barrier
    ds_read_b128 v[36:39], v12 offset:0
    ds_read_b128 v[108:111], v100 offset:0
    ds_read_b128 v[40:43], v13 offset:0
    ds_read_b128 v[112:115], v101 offset:0
    ds_read_b128 v[44:47], v14 offset:0
    ds_read_b128 v[116:119], v102 offset:0
    ds_read_b128 v[48:51], v15 offset:0
    ds_read_b128 v[120:123], v103 offset:0
    ds_read_b128 v[52:55], v16 offset:0
    ds_read_b128 v[124:127], v104 offset:0
    ds_read_b128 v[56:59], v17 offset:0
    ds_read_b128 v[128:131], v105 offset:0
    s_waitcnt lgkmcnt(10)
    v_mfma_f32_32x32x16_bf16 v[20:35], v[36:39], v[108:111], 0
    ds_read_b128 v[60:63], v18 offset:0
    ds_read_b128 v[132:135], v106 offset:0
    s_waitcnt lgkmcnt(10)
    v_mfma_f32_32x32x16_bf16 v[20:35], v[40:43], v[112:115], v[20:35]
    ds_read_b128 v[64:67], v19 offset:0
    ds_read_b128 v[136:139], v107 offset:0
    s_waitcnt lgkmcnt(10)
    v_mfma_f32_32x32x16_bf16 v[20:35], v[44:47], v[116:119], v[20:35]
    ds_read_b128 v[36:39], v12 offset:256
    ds_read_b128 v[108:111], v100 offset:256
    s_waitcnt lgkmcnt(10)
    v_mfma_f32_32x32x16_bf16 v[20:35], v[48:51], v[120:123], v[20:35]
    ds_read_b128 v[40:43], v13 offset:256
    ds_read_b128 v[112:115], v101 offset:256
    s_waitcnt lgkmcnt(10)
    v_mfma_f32_32x32x16_bf16 v[20:35], v[52:55], v[124:127], v[20:35]
    ds_read_b128 v[44:47], v14 offset:256
    ds_read_b128 v[116:119], v102 offset:256
    s_waitcnt lgkmcnt(10)
    v_mfma_f32_32x32x16_bf16 v[20:35], v[56:59], v[128:131], v[20:35]
    ds_read_b128 v[48:51], v15 offset:256
    ds_read_b128 v[120:123], v103 offset:256
    s_waitcnt lgkmcnt(10)
    v_mfma_f32_32x32x16_bf16 v[20:35], v[60:63], v[132:135], v[20:35]
    ds_read_b128 v[52:55], v16 offset:256
    ds_read_b128 v[124:127], v104 offset:256
    s_waitcnt lgkmcnt(10)
    v_mfma_f32_32x32x16_bf16 v[20:35], v[64:67], v[136:139], v[20:35]
    ds_read_b128 v[56:59], v17 offset:256
    ds_read_b128 v[128:131], v105 offset:256
    s_waitcnt lgkmcnt(10)
    v_mfma_f32_32x32x16_bf16 v[20:35], v[36:39], v[108:111], v[20:35]
    ds_read_b128 v[60:63], v18 offset:256
    ds_read_b128 v[132:135], v106 offset:256
    s_waitcnt lgkmcnt(10)
    v_mfma_f32_32x32x16_bf16 v[20:35], v[40:43], v[112:115], v[20:35]
    ds_read_b128 v[64:67], v19 offset:256
    ds_read_b128 v[136:139], v107 offset:256
    s_waitcnt lgkmcnt(10)
    v_mfma_f32_32x32x16_bf16 v[20:35], v[44:47], v[116:119], v[20:35]
    ds_read_b128 v[36:39], v12 offset:512
    ds_read_b128 v[108:111], v100 offset:512
    s_waitcnt lgkmcnt(10)
    v_mfma_f32_32x32x16_bf16 v[20:35], v[48:51], v[120:123], v[20:35]
    ds_read_b128 v[40:43], v13 offset:512
    ds_read_b128 v[112:115], v101 offset:512
    s_waitcnt lgkmcnt(10)
    v_mfma_f32_32x32x16_bf16 v[20:35], v[52:55], v[124:127], v[20:35]
    ds_read_b128 v[44:47], v14 offset:512
    ds_read_b128 v[116:119], v102 offset:512
    s_waitcnt lgkmcnt(10)
    v_mfma_f32_32x32x16_bf16 v[20:35], v[56:59], v[128:131], v[20:35]
    ds_read_b128 v[48:51], v15 offset:512
    ds_read_b128 v[120:123], v103 offset:512
    s_waitcnt lgkmcnt(10)
    v_mfma_f32_32x32x16_bf16 v[20:35], v[60:63], v[132:135], v[20:35]
    ds_read_b128 v[52:55], v16 offset:512
    ds_read_b128 v[124:127], v104 offset:512
    s_waitcnt lgkmcnt(10)
    v_mfma_f32_32x32x16_bf16 v[20:35], v[64:67], v[136:139], v[20:35]
    ds_read_b128 v[56:59], v17 offset:512
    ds_read_b128 v[128:131], v105 offset:512
    s_waitcnt lgkmcnt(10)
    v_mfma_f32_32x32x16_bf16 v[20:35], v[36:39], v[108:111], v[20:35]
    ds_read_b128 v[60:63], v18 offset:512
    ds_read_b128 v[132:135], v106 offset:512
    s_waitcnt lgkmcnt(10)
    v_mfma_f32_32x32x16_bf16 v[20:35], v[40:43], v[112:115], v[20:35]
    ds_read_b128 v[64:67], v19 offset:512
    ds_read_b128 v[136:139], v107 offset:512
    s_waitcnt lgkmcnt(10)
    v_mfma_f32_32x32x16_bf16 v[20:35], v[44:47], v[116:119], v[20:35]
    ds_read_b128 v[36:39], v12 offset:768
    ds_read_b128 v[108:111], v100 offset:768
    s_waitcnt lgkmcnt(10)
    v_mfma_f32_32x32x16_bf16 v[20:35], v[48:51], v[120:123], v[20:35]
    ds_read_b128 v[40:43], v13 offset:768
    ds_read_b128 v[112:115], v101 offset:768
    s_waitcnt lgkmcnt(10)
    v_mfma_f32_32x32x16_bf16 v[20:35], v[52:55], v[124:127], v[20:35]
    ds_read_b128 v[44:47], v14 offset:768
    ds_read_b128 v[116:119], v102 offset:768
    s_waitcnt lgkmcnt(10)
    v_mfma_f32_32x32x16_bf16 v[20:35], v[56:59], v[128:131], v[20:35]
    ds_read_b128 v[48:51], v15 offset:768
    ds_read_b128 v[120:123], v103 offset:768
    s_waitcnt lgkmcnt(10)
    v_mfma_f32_32x32x16_bf16 v[20:35], v[60:63], v[132:135], v[20:35]
    ds_read_b128 v[52:55], v16 offset:768
    ds_read_b128 v[124:127], v104 offset:768
    s_waitcnt lgkmcnt(10)
    v_mfma_f32_32x32x16_bf16 v[20:35], v[64:67], v[136:139], v[20:35]
    ds_read_b128 v[56:59], v17 offset:768
    ds_read_b128 v[128:131], v105 offset:768
    s_waitcnt lgkmcnt(10)
    v_mfma_f32_32x32x16_bf16 v[20:35], v[36:39], v[108:111], v[20:35]
    ds_read_b128 v[60:63], v18 offset:768
    ds_read_b128 v[132:135], v106 offset:768
    s_waitcnt lgkmcnt(10)
    v_mfma_f32_32x32x16_bf16 v[20:35], v[40:43], v[112:115], v[20:35]
    ds_read_b128 v[64:67], v19 offset:768
    ds_read_b128 v[136:139], v107 offset:768
    s_waitcnt lgkmcnt(10)
    v_mfma_f32_32x32x16_bf16 v[20:35], v[44:47], v[116:119], v[20:35]
    s_waitcnt lgkmcnt(8)
    v_mfma_f32_32x32x16_bf16 v[20:35], v[48:51], v[120:123], v[20:35]
    s_waitcnt lgkmcnt(6)
    v_mfma_f32_32x32x16_bf16 v[20:35], v[52:55], v[124:127], v[20:35]
    s_waitcnt lgkmcnt(4)
    v_mfma_f32_32x32x16_bf16 v[20:35], v[56:59], v[128:131], v[20:35]
    s_waitcnt lgkmcnt(2)
    v_mfma_f32_32x32x16_bf16 v[20:35], v[60:63], v[132:135], v[20:35]
    s_waitcnt lgkmcnt(0)
    v_mfma_f32_32x32x16_bf16 v[20:35], v[64:67], v[136:139], v[20:35]
    s_barrier
    s_lshl_b32 s62, s52, 3
    v_lshlrev_b32 v38, 5, v8
    v_add_u32 v38, 139264, v38
    v_lshl_add_u32 v39, v9, 2, v38
    v_add_u32 v39, s62, v39
    s_nop 7
    s_nop 2
    v_max3_f32 v36, v20, v21, v22
    v_max3_f32 v36, v36, v23, v24
    v_max3_f32 v36, v36, v25, v26
    v_max3_f32 v36, v36, v27, v28
    v_max3_f32 v36, v36, v29, v30
    v_max3_f32 v36, v36, v31, v32
    v_max3_f32 v36, v36, v33, v34
    v_max_f32 v36, v36, v35
    ds_write_b32 v39, v36
    s_waitcnt lgkmcnt(0)
    s_barrier
    ds_read_b128 v[40:43], v38
    ds_read_b128 v[44:47], v38 offset:16
    s_mov_b32 s63, 0x3e0293ee
    s_waitcnt lgkmcnt(0)
    v_max3_f32 v36, v40, v41, v42
    v_max3_f32 v36, v36, v43, v44
    v_max3_f32 v36, v36, v45, v46
    v_max_f32 v36, v36, v47
    v_mul_f32 v36, s63, v36
    v_fma_f32 v20, v20, s63, -v36
    v_fma_f32 v21, v21, s63, -v36
    v_fma_f32 v22, v22, s63, -v36
    v_fma_f32 v23, v23, s63, -v36
    v_fma_f32 v24, v24, s63, -v36
    v_fma_f32 v25, v25, s63, -v36
    v_fma_f32 v26, v26, s63, -v36
    v_fma_f32 v27, v27, s63, -v36
    v_fma_f32 v28, v28, s63, -v36
    v_fma_f32 v29, v29, s63, -v36
    v_fma_f32 v30, v30, s63, -v36
    v_fma_f32 v31, v31, s63, -v36
    v_fma_f32 v32, v32, s63, -v36
    v_fma_f32 v33, v33, s63, -v36
    v_fma_f32 v34, v34, s63, -v36
    v_fma_f32 v35, v35, s63, -v36
    v_exp_f32 v20, v20
    v_exp_f32 v21, v21
    v_exp_f32 v22, v22
    v_exp_f32 v23, v23
    v_exp_f32 v24, v24
    v_exp_f32 v25, v25
    v_exp_f32 v26, v26
    v_exp_f32 v27, v27
    v_exp_f32 v28, v28
    v_exp_f32 v29, v29
    v_exp_f32 v30, v30
    v_exp_f32 v31, v31
    v_exp_f32 v32, v32
    v_exp_f32 v33, v33
    v_exp_f32 v34, v34
    v_exp_f32 v35, v35
    s_nop 0
    v_add_f32 v37, v20, v21
    v_add_f32 v37, v37, v22
    v_add_f32 v37, v37, v23
    v_add_f32 v37, v37, v24
    v_add_f32 v37, v37, v25
    v_add_f32 v37, v37, v26
    v_add_f32 v37, v37, v27
    v_add_f32 v37, v37, v28
    v_add_f32 v37, v37, v29
    v_add_f32 v37, v37, v30
    v_add_f32 v37, v37, v31
    v_add_f32 v37, v37, v32
    v_add_f32 v37, v37, v33
    v_add_f32 v37, v37, v34
    v_add_f32 v37, v37, v35
    v_cvt_pk_bf16_f32 v40, v20, v21
    v_cvt_pk_bf16_f32 v41, v22, v23
    v_cvt_pk_bf16_f32 v42, v24, v25
    v_cvt_pk_bf16_f32 v43, v26, v27
    v_cvt_pk_bf16_f32 v44, v28, v29
    v_cvt_pk_bf16_f32 v45, v30, v31
    v_cvt_pk_bf16_f32 v46, v32, v33
    v_cvt_pk_bf16_f32 v47, v34, v35
    ds_write_b32 v39, v37 offset:1024
    s_lshl_b32 s62, s52, 11
    s_add_u32 s62, s62, 131072
    v_add_u32 v7, s62, v4
    ds_write_b128 v7, v[40:43]
    ds_write_b128 v7, v[44:47] offset:1024
    v_bfe_u32 v20, v1, 4, 1
    v_lshlrev_b32 v20, 1, v20
    v_bfe_u32 v21, v1, 1, 1
    v_or_b32 v20, v20, v21
    v_bfe_u32 v21, v1, 2, 2
    v_lshl_add_u32 v22, v21, 2, v9
    v_xor_b32 v20, v20, v22
    v_lshlrev_b32 v20, 4, v20
    v_lshl_add_u32 v21, v9, 2, v21
    v_lshl_add_u32 v20, v21, 10, v20
    v_and_b32 v21, 1, v1
    v_lshl_add_u32 v20, v21, 3, v20
    s_lshl_b32 s62, s52, 8
    v_add_u32 v12, s62, v20
    v_xor_b32 v13, 32, v12
    v_xor_b32 v14, 64, v12
    v_xor_b32 v15, 96, v12
    v_xor_b32 v16, 128, v12
    v_xor_b32 v17, 160, v12
    v_xor_b32 v18, 192, v12
    v_xor_b32 v19, 224, v12
    v_add_u32 v23, 131072, v4
    s_waitcnt lgkmcnt(0)
    s_barrier
    ds_read_b128 v[108:111], v23 offset:0
    ds_read_b128 v[112:115], v23 offset:1024
    ds_read_b128 v[116:119], v23 offset:2048
    ds_read_b128 v[120:123], v23 offset:3072
    ds_read_b128 v[124:127], v23 offset:4096
    ds_read_b128 v[128:131], v23 offset:5120
    ds_read_b128 v[132:135], v23 offset:6144
    ds_read_b128 v[136:139], v23 offset:7168
    ds_read_b128 v[40:43], v38 offset:1024
    ds_read_b128 v[44:47], v38 offset:1040
    v_and_b32 v5, 15, v8
    v_xor_b32 v5, v5, v9
    s_lshl_b32 s63, s52, 2
    v_xor_b32 v5, s63, v5
    v_lshlrev_b32 v5, 4, v5
    v_lshl_add_u32 v50, v8, 8, v5
    v_add_u32 v50, 147456, v50
    v_xor_b32 v51, 32, v50
    s_lshl_b32 s63, s52, 11
    s_add_u32 s64, s63, 147456
    v_add_u32 v52, s64, v4
    s_lshl_b32 s62, s2, 15
    s_add_u32 s62, s62, 0x100000
    s_add_u32 s62, s62, s63
    s_add_u32 s62, s62, s55
    v_lshrrev_b32 v5, 4, v1
    s_and_b32 s63, s52, 1
    s_lshl_b32 s63, s63, 3
    v_or_b32 v5, s63, v5
    v_lshlrev_b32 v5, 4, v5
    v_xor_b32 v53, v5, v4
    v_xor_b32 v54, 64, v53
    s_waitcnt lgkmcnt(0)
    v_add_f32 v37, v40, v41
    v_add_f32 v42, v42, v43
    v_add_f32 v44, v44, v45
    v_add_f32 v46, v46, v47
    v_add_f32 v37, v37, v42
    v_add_f32 v44, v44, v46
    v_add_f32 v37, v37, v44
    v_add_u32 v48, 0x10000, v12
    v_add_u32 v49, 0x10000, v13
    ds_read_b64_tr_b16 v[140:141], v12 offset:0
    ds_read_b64_tr_b16 v[142:143], v13 offset:8192
    ds_read_b64_tr_b16 v[144:145], v12 offset:16384
    ds_read_b64_tr_b16 v[146:147], v13 offset:24576
    ds_read_b64_tr_b16 v[148:149], v12 offset:32768
    ds_read_b64_tr_b16 v[150:151], v13 offset:40960
    ds_read_b64_tr_b16 v[152:153], v12 offset:49152
    ds_read_b64_tr_b16 v[154:155], v13 offset:57344
    s_waitcnt lgkmcnt(6)
    ds_read_b64_tr_b16 v[156:157], v48 offset:0
    ds_read_b64_tr_b16 v[158:159], v49 offset:8192
    ds_read_b64_tr_b16 v[160:161], v48 offset:16384
    ds_read_b64_tr_b16 v[162:163], v49 offset:24576
    ds_read_b64_tr_b16 v[164:165], v48 offset:32768
    ds_read_b64_tr_b16 v[166:167], v49 offset:40960
    ds_read_b64_tr_b16 v[168:169], v48 offset:49152
    ds_read_b64_tr_b16 v[170:171], v49 offset:57344
    s_waitcnt lgkmcnt(0)
    v_mfma_f32_32x32x16_bf16 v[204:219], v[140:143], v[108:111], 0
    v_mfma_f32_32x32x16_bf16 v[204:219], v[144:147], v[112:115], v[204:219]
    v_mfma_f32_32x32x16_bf16 v[204:219], v[148:151], v[116:119], v[204:219]
    v_mfma_f32_32x32x16_bf16 v[204:219], v[152:155], v[120:123], v[204:219]
    v_mfma_f32_32x32x16_bf16 v[204:219], v[156:159], v[124:127], v[204:219]
    v_mfma_f32_32x32x16_bf16 v[204:219], v[160:163], v[128:131], v[204:219]
    v_mfma_f32_32x32x16_bf16 v[204:219], v[164:167], v[132:135], v[204:219]
    v_mfma_f32_32x32x16_bf16 v[204:219], v[168:171], v[136:139], v[204:219]
    v_add_u32 v48, 0x10000, v14
    v_add_u32 v49, 0x10000, v15
    ds_read_b64_tr_b16 v[172:173], v14 offset:0
    ds_read_b64_tr_b16 v[174:175], v15 offset:8192
    ds_read_b64_tr_b16 v[176:177], v14 offset:16384
    ds_read_b64_tr_b16 v[178:179], v15 offset:24576
    ds_read_b64_tr_b16 v[180:181], v14 offset:32768
    ds_read_b64_tr_b16 v[182:183], v15 offset:40960
    ds_read_b64_tr_b16 v[184:185], v14 offset:49152
    ds_read_b64_tr_b16 v[186:187], v15 offset:57344
    s_waitcnt lgkmcnt(6)
    ds_read_b64_tr_b16 v[188:189], v48 offset:0
    ds_read_b64_tr_b16 v[190:191], v49 offset:8192
    ds_read_b64_tr_b16 v[192:193], v48 offset:16384
    ds_read_b64_tr_b16 v[194:195], v49 offset:24576
    ds_read_b64_tr_b16 v[196:197], v48 offset:32768
    ds_read_b64_tr_b16 v[198:199], v49 offset:40960
    ds_read_b64_tr_b16 v[200:201], v48 offset:49152
    ds_read_b64_tr_b16 v[202:203], v49 offset:57344
    v_cvt_pk_bf16_f32 v56, v204, v205
    v_cvt_pk_bf16_f32 v57, v206, v207
    v_cvt_pk_bf16_f32 v58, v208, v209
    v_cvt_pk_bf16_f32 v59, v210, v211
    s_nop 1
    v_permlane32_swap_b32 v56, v58
    v_permlane32_swap_b32 v57, v59
    ds_write_b128 v50, v[56:59] offset:0
    v_cvt_pk_bf16_f32 v60, v212, v213
    v_cvt_pk_bf16_f32 v61, v214, v215
    v_cvt_pk_bf16_f32 v62, v216, v217
    v_cvt_pk_bf16_f32 v63, v218, v219
    s_nop 1
    v_permlane32_swap_b32 v60, v62
    v_permlane32_swap_b32 v61, v63
    ds_write_b128 v51, v[60:63] offset:0
    s_waitcnt lgkmcnt(0)
    s_barrier
    ds_read_b128 v[64:67], v52 offset:0
    ds_read_b128 v[68:71], v52 offset:1024
    s_waitcnt lgkmcnt(0)
    buffer_store_dwordx4 v[64:67], v53, s[48:51], s62 offen sc0 sc1
    buffer_store_dwordx4 v[68:71], v54, s[48:51], s62 offen offset:1024 sc0 sc1
    s_add_u32 s62, s62, 8192
    s_waitcnt lgkmcnt(0)
    v_mfma_f32_32x32x16_bf16 v[220:235], v[172:175], v[108:111], 0
    v_mfma_f32_32x32x16_bf16 v[220:235], v[176:179], v[112:115], v[220:235]
    v_mfma_f32_32x32x16_bf16 v[220:235], v[180:183], v[116:119], v[220:235]
    v_mfma_f32_32x32x16_bf16 v[220:235], v[184:187], v[120:123], v[220:235]
    v_mfma_f32_32x32x16_bf16 v[220:235], v[188:191], v[124:127], v[220:235]
    v_mfma_f32_32x32x16_bf16 v[220:235], v[192:195], v[128:131], v[220:235]
    v_mfma_f32_32x32x16_bf16 v[220:235], v[196:199], v[132:135], v[220:235]
    v_mfma_f32_32x32x16_bf16 v[220:235], v[200:203], v[136:139], v[220:235]
    v_add_u32 v48, 0x10000, v16
    v_add_u32 v49, 0x10000, v17
    ds_read_b64_tr_b16 v[140:141], v16 offset:0
    ds_read_b64_tr_b16 v[142:143], v17 offset:8192
    ds_read_b64_tr_b16 v[144:145], v16 offset:16384
    ds_read_b64_tr_b16 v[146:147], v17 offset:24576
    ds_read_b64_tr_b16 v[148:149], v16 offset:32768
    ds_read_b64_tr_b16 v[150:151], v17 offset:40960
    ds_read_b64_tr_b16 v[152:153], v16 offset:49152
    ds_read_b64_tr_b16 v[154:155], v17 offset:57344
    s_waitcnt lgkmcnt(6)
    ds_read_b64_tr_b16 v[156:157], v48 offset:0
    ds_read_b64_tr_b16 v[158:159], v49 offset:8192
    ds_read_b64_tr_b16 v[160:161], v48 offset:16384
    ds_read_b64_tr_b16 v[162:163], v49 offset:24576
    ds_read_b64_tr_b16 v[164:165], v48 offset:32768
    ds_read_b64_tr_b16 v[166:167], v49 offset:40960
    ds_read_b64_tr_b16 v[168:169], v48 offset:49152
    ds_read_b64_tr_b16 v[170:171], v49 offset:57344
    v_cvt_pk_bf16_f32 v56, v220, v221
    v_cvt_pk_bf16_f32 v57, v222, v223
    v_cvt_pk_bf16_f32 v58, v224, v225
    v_cvt_pk_bf16_f32 v59, v226, v227
    s_nop 1
    v_permlane32_swap_b32 v56, v58
    v_permlane32_swap_b32 v57, v59
    ds_write_b128 v50, v[56:59] offset:8192
    v_cvt_pk_bf16_f32 v60, v228, v229
    v_cvt_pk_bf16_f32 v61, v230, v231
    v_cvt_pk_bf16_f32 v62, v232, v233
    v_cvt_pk_bf16_f32 v63, v234, v235
    s_nop 1
    v_permlane32_swap_b32 v60, v62
    v_permlane32_swap_b32 v61, v63
    ds_write_b128 v51, v[60:63] offset:8192
    s_waitcnt lgkmcnt(0)
    s_barrier
    ds_read_b128 v[72:75], v52 offset:8192
    ds_read_b128 v[76:79], v52 offset:9216
    s_waitcnt lgkmcnt(0)
    buffer_store_dwordx4 v[72:75], v53, s[48:51], s62 offen sc0 sc1
    buffer_store_dwordx4 v[76:79], v54, s[48:51], s62 offen offset:1024 sc0 sc1
    s_add_u32 s62, s62, 8192
    s_waitcnt lgkmcnt(0)
    v_mfma_f32_32x32x16_bf16 v[204:219], v[140:143], v[108:111], 0
    v_mfma_f32_32x32x16_bf16 v[204:219], v[144:147], v[112:115], v[204:219]
    v_mfma_f32_32x32x16_bf16 v[204:219], v[148:151], v[116:119], v[204:219]
    v_mfma_f32_32x32x16_bf16 v[204:219], v[152:155], v[120:123], v[204:219]
    v_mfma_f32_32x32x16_bf16 v[204:219], v[156:159], v[124:127], v[204:219]
    v_mfma_f32_32x32x16_bf16 v[204:219], v[160:163], v[128:131], v[204:219]
    v_mfma_f32_32x32x16_bf16 v[204:219], v[164:167], v[132:135], v[204:219]
    v_mfma_f32_32x32x16_bf16 v[204:219], v[168:171], v[136:139], v[204:219]
    v_add_u32 v48, 0x10000, v18
    v_add_u32 v49, 0x10000, v19
    ds_read_b64_tr_b16 v[172:173], v18 offset:0
    ds_read_b64_tr_b16 v[174:175], v19 offset:8192
    ds_read_b64_tr_b16 v[176:177], v18 offset:16384
    ds_read_b64_tr_b16 v[178:179], v19 offset:24576
    ds_read_b64_tr_b16 v[180:181], v18 offset:32768
    ds_read_b64_tr_b16 v[182:183], v19 offset:40960
    ds_read_b64_tr_b16 v[184:185], v18 offset:49152
    ds_read_b64_tr_b16 v[186:187], v19 offset:57344
    s_waitcnt lgkmcnt(6)
    ds_read_b64_tr_b16 v[188:189], v48 offset:0
    ds_read_b64_tr_b16 v[190:191], v49 offset:8192
    ds_read_b64_tr_b16 v[192:193], v48 offset:16384
    ds_read_b64_tr_b16 v[194:195], v49 offset:24576
    ds_read_b64_tr_b16 v[196:197], v48 offset:32768
    ds_read_b64_tr_b16 v[198:199], v49 offset:40960
    ds_read_b64_tr_b16 v[200:201], v48 offset:49152
    ds_read_b64_tr_b16 v[202:203], v49 offset:57344
    v_cvt_pk_bf16_f32 v56, v204, v205
    v_cvt_pk_bf16_f32 v57, v206, v207
    v_cvt_pk_bf16_f32 v58, v208, v209
    v_cvt_pk_bf16_f32 v59, v210, v211
    s_nop 1
    v_permlane32_swap_b32 v56, v58
    v_permlane32_swap_b32 v57, v59
    ds_write_b128 v50, v[56:59] offset:0
    v_cvt_pk_bf16_f32 v60, v212, v213
    v_cvt_pk_bf16_f32 v61, v214, v215
    v_cvt_pk_bf16_f32 v62, v216, v217
    v_cvt_pk_bf16_f32 v63, v218, v219
    s_nop 1
    v_permlane32_swap_b32 v60, v62
    v_permlane32_swap_b32 v61, v63
    ds_write_b128 v51, v[60:63] offset:0
    s_waitcnt lgkmcnt(0)
    s_barrier
    ds_read_b128 v[64:67], v52 offset:0
    ds_read_b128 v[68:71], v52 offset:1024
    s_waitcnt lgkmcnt(0)
    buffer_store_dwordx4 v[64:67], v53, s[48:51], s62 offen sc0 sc1
    buffer_store_dwordx4 v[68:71], v54, s[48:51], s62 offen offset:1024 sc0 sc1
    s_add_u32 s62, s62, 8192
    s_waitcnt lgkmcnt(0)
    v_mfma_f32_32x32x16_bf16 v[220:235], v[172:175], v[108:111], 0
    v_mfma_f32_32x32x16_bf16 v[220:235], v[176:179], v[112:115], v[220:235]
    v_mfma_f32_32x32x16_bf16 v[220:235], v[180:183], v[116:119], v[220:235]
    v_mfma_f32_32x32x16_bf16 v[220:235], v[184:187], v[120:123], v[220:235]
    v_mfma_f32_32x32x16_bf16 v[220:235], v[188:191], v[124:127], v[220:235]
    v_mfma_f32_32x32x16_bf16 v[220:235], v[192:195], v[128:131], v[220:235]
    v_mfma_f32_32x32x16_bf16 v[220:235], v[196:199], v[132:135], v[220:235]
    v_mfma_f32_32x32x16_bf16 v[220:235], v[200:203], v[136:139], v[220:235]
    s_nop 7
    s_nop 7
    v_cvt_pk_bf16_f32 v56, v220, v221
    v_cvt_pk_bf16_f32 v57, v222, v223
    v_cvt_pk_bf16_f32 v58, v224, v225
    v_cvt_pk_bf16_f32 v59, v226, v227
    s_nop 1
    v_permlane32_swap_b32 v56, v58
    v_permlane32_swap_b32 v57, v59
    ds_write_b128 v50, v[56:59] offset:8192
    v_cvt_pk_bf16_f32 v60, v228, v229
    v_cvt_pk_bf16_f32 v61, v230, v231
    v_cvt_pk_bf16_f32 v62, v232, v233
    v_cvt_pk_bf16_f32 v63, v234, v235
    s_nop 1
    v_permlane32_swap_b32 v60, v62
    v_permlane32_swap_b32 v61, v63
    ds_write_b128 v51, v[60:63] offset:8192
    s_waitcnt lgkmcnt(0)
    s_barrier
    ds_read_b128 v[72:75], v52 offset:8192
    ds_read_b128 v[76:79], v52 offset:9216
    s_waitcnt lgkmcnt(0)
    buffer_store_dwordx4 v[72:75], v53, s[48:51], s62 offen sc0 sc1
    buffer_store_dwordx4 v[76:79], v54, s[48:51], s62 offen offset:1024 sc0 sc1
    s_cmp_lg_u32 s52, 0
    s_cbranch_scc1 L_noml8
    v_lshlrev_b32 v7, 9, v8
    s_lshr_b32 s62, s2, 6
    s_lshl_b32 s62, s62, 14
    s_and_b32 s63, s2, 63
    s_lshl_b32 s63, s63, 3
    s_add_u32 s62, s62, s63
    s_add_u32 s62, s62, 0x10000
    s_add_u32 s62, s62, s55
    v_cmp_gt_u32 vcc, 32, v1
    s_and_saveexec_b64 s[72:73], vcc
    buffer_store_dwordx2 v[36:37], v7, s[48:51], s62 offen sc0 sc1
    s_mov_b64 exec, s[72:73]
L_noml8:
    s_waitcnt vmcnt(0)
    s_barrier
    s_cmp_lg_u32 s52, 0
    s_cbranch_scc1 L_pub9
    v_lshlrev_b32 v6, 12, v1
    s_mov_b64 s[72:73], exec
    s_mov_b64 exec, 1
    s_mov_b64 exec, 0xff
    s_lshl_b32 s62, s54, 17
    s_and_b32 s63, s2, 15
    s_lshl_b32 s63, s63, 8
    s_add_u32 s62, s62, s63
    s_add_u32 s62, s62, 0x1208000
    v_mov_b32 v5, 1
    buffer_atomic_add v5, v6, s[48:51], s62 offen sc1
    s_mov_b64 exec, s[72:73]
L_pub9:
    s_cmp_lg_u32 s52, 0
    s_cbranch_scc1 L_wf11
    s_mov_b32 s63, 400000
    s_sub_u32 s62, s54, 0
    s_lshl_b32 s62, s62, 17
    s_add_u32 s62, s62, 0x1208000
    s_and_b32 s64, s2, 7
    s_lshl_b32 s64, s64, 12
    s_add_u32 s62, s62, s64
    v_and_b32 v5, 15, v1
    v_mov_b32 v6, 8
    v_lshlrev_b32 v5, 8, v5
L_poll12:
    buffer_load_dword v196, v5, s[48:51], s62 offen sc0 sc1
    s_waitcnt vmcnt(0)
    v_cmp_ne_u32 vcc, v6, v196
    s_cbranch_vccz L_pdone13
    s_sub_u32 s63, s63, 1
    s_cmp_lg_u32 s63, 0
    s_cbranch_scc1 L_poll12
L_pdone13:
L_wf11:
    s_barrier
    v_lshrrev_b32 v5, 2, v1
    v_and_b32 v6, 3, v1
    v_bfe_u32 v7, v5, 3, 1
    v_lshlrev_b32 v7, 1, v7
    v_xor_b32 v6, v6, v7
    v_lshlrev_b32 v6, 4, v6
    v_lshl_add_u32 v8, v5, 15, v6
    v_lshlrev_b32 v5, 3, v1
    s_lshl_b32 s62, s56, 9
    s_add_u32 s62, s62, 0x10000
    s_add_u32 s62, s62, s55
    buffer_load_dwordx2 v[10:11], v5, s[48:51], s62 offen sc0 sc1
    s_add_u32 s62, s62, 0x4000
    buffer_load_dwordx2 v[12:13], v5, s[48:51], s62 offen sc0 sc1
    s_lshl_b32 s70, s56, 8
    s_lshl_b32 s62, s58, 6
    s_add_u32 s70, s70, s62
    s_lshl_b32 s62, s52, 13
    s_add_u32 s70, s70, s62
    s_add_u32 s70, s70, 0x100000
    s_add_u32 s70, s70, s55
    buffer_load_dwordx4 v[112:115], v8, s[48:51], s70 offen sc0 sc1
    s_add_u32 s70, s70, 0x80000
    buffer_load_dwordx4 v[116:119], v8, s[48:51], s70 offen sc0 sc1
    s_add_u32 s70, s70, 0x80000
    buffer_load_dwordx4 v[120:123], v8, s[48:51], s70 offen sc0 sc1
    s_add_u32 s70, s70, 0x80000
    buffer_load_dwordx4 v[124:127], v8, s[48:51], s70 offen sc0 sc1
    s_add_u32 s70, s70, 0x80000
    buffer_load_dwordx4 v[128:131], v8, s[48:51], s70 offen sc0 sc1
    s_add_u32 s70, s70, 0x80000
    buffer_load_dwordx4 v[132:135], v8, s[48:51], s70 offen sc0 sc1
    s_add_u32 s70, s70, 0x80000
    buffer_load_dwordx4 v[136:139], v8, s[48:51], s70 offen sc0 sc1
    s_add_u32 s70, s70, 0x80000
    buffer_load_dwordx4 v[140:143], v8, s[48:51], s70 offen sc0 sc1
    s_lshl_b32 s68, s52, 9
    s_add_u32 s68, s68, 147456
    v_mov_b32 v18, 0
    v_lshlrev_b32 v5, 1, v1
    v_add_u32 v30, s68, v5
    ds_write_b16 v30, v18 offset:256
    s_lshl_b32 s64, s52, 12
    s_add_u32 s64, s64, 131072
    v_add_u32 v31, s64, v4
    v_lshrrev_b32 v5, 4, v1
    v_bfe_u32 v6, v1, 2, 2
    v_lshl_add_u32 v20, v5, 3, v6
    v_lshlrev_b32 v20, 6, v20
    v_and_b32 v5, 1, v5
    v_lshl_add_u32 v20, v5, 5, v20
    v_and_b32 v6, 3, v1
    v_lshl_add_u32 v20, v6, 3, v20
    v_add_u32 v20, s64, v20
    v_xor_b32 v21, 32, v20
    v_and_b32 v6, 15, v1
    v_lshrrev_b32 v5, 4, v1
    v_lshlrev_b32 v5, 4, v5
    v_add_u32 v5, s68, v5
    v_add_u32 v7, 128, v5
    s_add_u32 s67, s68, 256
    v_mov_b32 v18, s67
    v_cmp_eq_u32 vcc, 0, v6
    s_nop 1
    v_cndmask_b32 v28, v18, v5, vcc
    v_cmp_eq_u32 vcc, 1, v6
    s_nop 1
    v_cndmask_b32 v29, v18, v7, vcc
    s_waitcnt vmcnt(8)
    v_mov_b32 v16, v10
    v_mov_b32 v17, v12
    s_nop 1
    v_max_f32_dpp v16, v16, v16 quad_perm:[1,0,3,2] row_mask:0xf bank_mask:0xf
    v_max_f32_dpp v17, v17, v17 quad_perm:[1,0,3,2] row_mask:0xf bank_mask:0xf
    s_nop 0
    v_max_f32_dpp v16, v16, v16 quad_perm:[2,3,0,1] row_mask:0xf bank_mask:0xf
    v_max_f32_dpp v17, v17, v17 quad_perm:[2,3,0,1] row_mask:0xf bank_mask:0xf
    s_nop 0
    v_max_f32_dpp v16, v16, v16 row_half_mirror row_mask:0xf bank_mask:0xf
    v_max_f32_dpp v17, v17, v17 row_half_mirror row_mask:0xf bank_mask:0xf
    s_nop 0
    v_max_f32_dpp v16, v16, v16 row_mirror row_mask:0xf bank_mask:0xf
    v_max_f32_dpp v17, v17, v17 row_mirror row_mask:0xf bank_mask:0xf
    s_nop 0
    v_mov_b32 v18, v16
    v_mov_b32 v19, v17
    s_nop 1
    v_permlane16_swap_b32 v16, v18
    v_permlane16_swap_b32 v17, v19
    s_nop 0
    v_max_f32 v16, v16, v18
    v_max_f32 v17, v17, v19
    s_nop 0
    v_mov_b32 v18, v16
    v_mov_b32 v19, v17
    s_nop 1
    v_permlane32_swap_b32 v16, v18
    v_permlane32_swap_b32 v17, v19
    s_nop 0
    v_max_f32 v16, v16, v18
    v_max_f32 v17, v17, v19
    s_nop 0
    v_sub_f32 v14, v10, v16
    v_sub_f32 v15, v12, v17
    v_exp_f32 v14, v14
    v_exp_f32 v15, v15
    s_nop 0
    v_cvt_pk_bf16_f32 v14, v14, v14
    v_cvt_pk_bf16_f32 v15, v15, v15
    ds_write_b16 v30, v14
    ds_write_b16 v30, v15 offset:128
    v_lshlrev_b32 v14, 16, v14
    v_lshlrev_b32 v15, 16, v15
    v_mul_f32 v16, v14, v11
    v_mul_f32 v17, v15, v13
    s_nop 1
    v_add_f32_dpp v16, v16, v16 quad_perm:[1,0,3,2] row_mask:0xf bank_mask:0xf
    v_add_f32_dpp v17, v17, v17 quad_perm:[1,0,3,2] row_mask:0xf bank_mask:0xf
    s_nop 0
    v_add_f32_dpp v16, v16, v16 quad_perm:[2,3,0,1] row_mask:0xf bank_mask:0xf
    v_add_f32_dpp v17, v17, v17 quad_perm:[2,3,0,1] row_mask:0xf bank_mask:0xf
    s_nop 0
    v_add_f32_dpp v16, v16, v16 row_half_mirror row_mask:0xf bank_mask:0xf
    v_add_f32_dpp v17, v17, v17 row_half_mirror row_mask:0xf bank_mask:0xf
    s_nop 0
    v_add_f32_dpp v16, v16, v16 row_mirror row_mask:0xf bank_mask:0xf
    v_add_f32_dpp v17, v17, v17 row_mirror row_mask:0xf bank_mask:0xf
    s_nop 0
    v_mov_b32 v18, v16
    v_mov_b32 v19, v17
    s_nop 1
    v_permlane16_swap_b32 v16, v18
    v_permlane16_swap_b32 v17, v19
    s_nop 0
    v_add_f32 v16, v16, v18
    v_add_f32 v17, v17, v19
    s_nop 0
    v_mov_b32 v18, v16
    v_mov_b32 v19, v17
    s_nop 1
    v_permlane32_swap_b32 v16, v18
    v_permlane32_swap_b32 v17, v19
    s_nop 0
    v_add_f32 v16, v16, v18
    v_add_f32 v17, v17, v19
    s_nop 0
    v_rcp_f32 v16, v16
    v_rcp_f32 v17, v17
    v_cmp_eq_u32 vcc, 0, v6
    s_nop 1
    v_cndmask_b32 v16, v17, v16, vcc
    s_waitcnt lgkmcnt(0)
    ds_read_b128 v[32:35], v28 offset:0
    ds_read_b128 v[36:39], v28 offset:64
    ds_read_b128 v[40:43], v29 offset:0
    ds_read_b128 v[44:47], v29 offset:64
    s_waitcnt vmcnt(7)
    ds_write_b128 v31, v[112:115] offset:0
    s_waitcnt vmcnt(6)
    ds_write_b128 v31, v[116:119] offset:1024
    s_waitcnt vmcnt(5)
    ds_write_b128 v31, v[120:123] offset:2048
    s_waitcnt vmcnt(4)
    ds_write_b128 v31, v[124:127] offset:3072
    s_waitcnt lgkmcnt(0)
    ds_read_b64_tr_b16 v[64:65], v20 offset:0
    ds_read_b64_tr_b16 v[66:67], v20 offset:256
    ds_read_b64_tr_b16 v[68:69], v21 offset:0
    ds_read_b64_tr_b16 v[70:71], v21 offset:256
    ds_read_b64_tr_b16 v[72:73], v20 offset:2048
    ds_read_b64_tr_b16 v[74:75], v20 offset:2304
    ds_read_b64_tr_b16 v[76:77], v21 offset:2048
    ds_read_b64_tr_b16 v[78:79], v21 offset:2304
    s_waitcnt lgkmcnt(0)
    v_mfma_f32_16x16x32_bf16 v[48:51], v[64:67], v[32:35], 0
    v_mfma_f32_16x16x32_bf16 v[52:55], v[68:71], v[32:35], 0
    v_mfma_f32_16x16x32_bf16 v[48:51], v[72:75], v[36:39], v[48:51]
    v_mfma_f32_16x16x32_bf16 v[52:55], v[76:79], v[36:39], v[52:55]
    s_waitcnt vmcnt(3)
    ds_write_b128 v31, v[128:131] offset:0
    s_waitcnt vmcnt(2)
    ds_write_b128 v31, v[132:135] offset:1024
    s_waitcnt vmcnt(1)
    ds_write_b128 v31, v[136:139] offset:2048
    s_waitcnt vmcnt(0)
    ds_write_b128 v31, v[140:143] offset:3072
    s_waitcnt lgkmcnt(0)
    ds_read_b64_tr_b16 v[64:65], v20 offset:0
    ds_read_b64_tr_b16 v[66:67], v20 offset:256
    ds_read_b64_tr_b16 v[68:69], v21 offset:0
    ds_read_b64_tr_b16 v[70:71], v21 offset:256
    ds_read_b64_tr_b16 v[72:73], v20 offset:2048
    ds_read_b64_tr_b16 v[74:75], v20 offset:2304
    ds_read_b64_tr_b16 v[76:77], v21 offset:2048
    ds_read_b64_tr_b16 v[78:79], v21 offset:2304
    s_waitcnt lgkmcnt(0)
    v_mfma_f32_16x16x32_bf16 v[48:51], v[64:67], v[40:43], v[48:51]
    v_mfma_f32_16x16x32_bf16 v[52:55], v[68:71], v[40:43], v[52:55]
    v_mfma_f32_16x16x32_bf16 v[48:51], v[72:75], v[44:47], v[48:51]
    v_mfma_f32_16x16x32_bf16 v[52:55], v[76:79], v[44:47], v[52:55]
    v_lshrrev_b32 v5, 4, v1
    v_lshlrev_b32 v7, 8, v6
    v_lshl_add_u32 v7, v5, 3, v7
    s_lshl_b32 s67, s52, 6
    s_add_u32 s67, s67, 149504
    v_add_u32 v31, s67, v7
    v_cmp_gt_u32 vcc, 2, v6
    s_and_saveexec_b64 s[72:73], vcc
    s_nop 2
    v_mul_f32 v48, v48, v16
    v_mul_f32 v49, v49, v16
    v_mul_f32 v50, v50, v16
    v_mul_f32 v51, v51, v16
    v_cvt_pk_bf16_f32 v48, v48, v49
    v_cvt_pk_bf16_f32 v49, v50, v51
    ds_write_b64 v31, v[48:49] offset:0
    v_mul_f32 v52, v52, v16
    v_mul_f32 v53, v53, v16
    v_mul_f32 v54, v54, v16
    v_mul_f32 v55, v55, v16
    v_cvt_pk_bf16_f32 v52, v52, v53
    v_cvt_pk_bf16_f32 v53, v54, v55
    ds_write_b64 v31, v[52:53] offset:32
    s_mov_b64 exec, s[72:73]
    v_and_b32 v28, 1, v1
    v_mul_u32_u24 v28, 256, v28
    v_lshrrev_b32 v5, 4, v1
    v_lshl_add_u32 v28, v5, 4, v28
    v_add_u32 v28, 149504, v28
    s_waitcnt lgkmcnt(0)
    s_barrier
    ds_read_b128 v[32:35], v28 offset:0
    ds_read_b128 v[36:39], v28 offset:64
    ds_read_b128 v[40:43], v28 offset:128
    ds_read_b128 v[44:47], v28 offset:192
    s_waitcnt lgkmcnt(0)
    v_mfma_f32_16x16x32_bf16 v[48:51], a[128:131], v[32:35], 0
    v_mfma_f32_16x16x32_bf16 v[52:55], a[132:135], v[32:35], 0
    v_mfma_f32_16x16x32_bf16 v[48:51], a[136:139], v[36:39], v[48:51]
    v_mfma_f32_16x16x32_bf16 v[52:55], a[140:143], v[36:39], v[52:55]
    v_mfma_f32_16x16x32_bf16 v[48:51], a[144:147], v[40:43], v[48:51]
    v_mfma_f32_16x16x32_bf16 v[52:55], a[148:151], v[40:43], v[52:55]
    v_mfma_f32_16x16x32_bf16 v[48:51], a[152:155], v[44:47], v[48:51]
    v_mfma_f32_16x16x32_bf16 v[52:55], a[156:159], v[44:47], v[52:55]
    s_and_saveexec_b64 s[72:73], vcc
    s_nop 6
    v_cvt_pk_bf16_f32 v48, v48, v49
    v_cvt_pk_bf16_f32 v49, v50, v51
    ds_write_b64 v31, v[48:49] offset:512
    v_cvt_pk_bf16_f32 v52, v52, v53
    v_cvt_pk_bf16_f32 v53, v54, v55
    ds_write_b64 v31, v[52:53] offset:544
    s_mov_b64 exec, s[72:73]
    s_waitcnt lgkmcnt(0)
    s_barrier
    ds_read_b128 v[32:35], v28 offset:512
    ds_read_b128 v[36:39], v28 offset:576
    ds_read_b128 v[40:43], v28 offset:640
    ds_read_b128 v[44:47], v28 offset:704
    s_waitcnt lgkmcnt(0)
    v_mfma_f32_16x16x32_bf16 v[48:51], a[160:163], v[32:35], 0
    v_mfma_f32_16x16x32_bf16 v[52:55], a[164:167], v[32:35], 0
    v_mfma_f32_16x16x32_bf16 v[56:59], a[168:171], v[32:35], 0
    v_mfma_f32_16x16x32_bf16 v[60:63], a[172:175], v[32:35], 0
    v_mfma_f32_16x16x32_bf16 v[48:51], a[176:179], v[36:39], v[48:51]
    v_mfma_f32_16x16x32_bf16 v[52:55], a[180:183], v[36:39], v[52:55]
    v_mfma_f32_16x16x32_bf16 v[56:59], a[184:187], v[36:39], v[56:59]
    v_mfma_f32_16x16x32_bf16 v[60:63], a[188:191], v[36:39], v[60:63]
    v_mfma_f32_16x16x32_bf16 v[48:51], a[192:195], v[40:43], v[48:51]
    v_mfma_f32_16x16x32_bf16 v[52:55], a[196:199], v[40:43], v[52:55]
    v_mfma_f32_16x16x32_bf16 v[56:59], a[200:203], v[40:43], v[56:59]
    v_mfma_f32_16x16x32_bf16 v[60:63], a[204:207], v[40:43], v[60:63]
    v_mfma_f32_16x16x32_bf16 v[48:51], a[208:211], v[44:47], v[48:51]
    v_mfma_f32_16x16x32_bf16 v[52:55], a[212:215], v[44:47], v[52:55]
    v_mfma_f32_16x16x32_bf16 v[56:59], a[216:219], v[44:47], v[56:59]
    v_mfma_f32_16x16x32_bf16 v[60:63], a[220:223], v[44:47], v[60:63]
    s_lshl_b32 s67, s52, 9
    s_add_u32 s67, s67, 150528
    s_lshl_b32 s68, s58, 1
    s_and_b32 s69, s56, 1
    s_add_u32 s68, s68, s69
    s_and_b32 s68, s68, 7
    s_lshl_b32 s68, s68, 12
    s_lshl_b32 s69, s59, 10
    s_add_u32 s68, s68, s69
    s_lshl_b32 s69, s52, 8
    s_add_u32 s68, s68, s69
    s_add_u32 s68, s68, 0x20000
    s_add_u32 s68, s68, s55
    v_and_b32 v6, 15, v1
    v_lshrrev_b32 v5, 4, v1
    v_mul_u32_u24 v14, 256, v6
    v_lshl_add_u32 v14, v5, 4, v14
    v_add_u32 v14, s67, v14
    v_cmp_gt_u32 vcc, 2, v6
    s_and_saveexec_b64 s[72:73], vcc
    s_nop 4
    ds_write_b128 v14, v[48:51] offset:0
    ds_write_b128 v14, v[52:55] offset:64
    ds_write_b128 v14, v[56:59] offset:128
    ds_write_b128 v14, v[60:63] offset:192
    s_mov_b64 exec, s[72:73]
    v_lshlrev_b32 v5, 2, v1
    v_add_u32 v14, s67, v5
    s_waitcnt lgkmcnt(0)
    ds_read_b32 v15, v14 offset:0
    ds_read_b32 v16, v14 offset:256
    s_waitcnt lgkmcnt(1)
    buffer_atomic_add_f32 v15, v5, s[48:51], s68 offen offset:0
    s_waitcnt lgkmcnt(0)
    buffer_atomic_add_f32 v16, v5, s[48:51], s68 offen offset:2048
    s_waitcnt vmcnt(0)
    s_barrier
    s_cmp_lg_u32 s52, 0
    s_cbranch_scc1 L_pub16
    v_lshlrev_b32 v6, 12, v1
    s_mov_b64 s[72:73], exec
    s_mov_b64 exec, 1
    s_mov_b64 exec, 0xff
    s_lshl_b32 s62, s54, 17
    s_and_b32 s63, s2, 15
    s_lshl_b32 s63, s63, 8
    s_add_u32 s62, s62, s63
    s_add_u32 s62, s62, 0x1210000
    v_mov_b32 v5, 1
    buffer_atomic_add v5, v6, s[48:51], s62 offen sc1
    s_mov_b64 exec, s[72:73]
L_pub16:
    s_cmp_eq_u32 s54, 1
    s_cbranch_scc1 L_end
    s_mov_b32 s54, 1
    s_mov_b32 s55, 0x800000
    s_branch L_bloop
L_nflow:
    v_lshrrev_b32 v5, 4, v1
    v_and_b32 v6, 15, v1
    v_lshlrev_b32 v7, 1, v5
    v_xor_b32 v6, v6, v7
    v_lshlrev_b32 v6, 4, v6
    v_lshl_add_u32 v8, v5, 13, v6
    v_xor_b32 v9, 0x80, v8
    v_lshrrev_b32 v5, 4, v1
    v_and_b32 v6, 15, v1
    v_lshlrev_b32 v10, 13, v6
    v_lshl_add_u32 v10, v5, 4, v10
    s_lshl_b32 s62, s56, 8
    s_and_b32 s63, s57, 3
    s_lshl_b32 s63, s63, 7
    s_lshl_b32 s64, s52, 5
    s_add_u32 s63, s63, s64
    s_lshl_b32 s63, s63, 13
    s_add_u32 s63, s63, s62
    s_add_u32 s64, s63, 0x20000
    s_lshl_b32 s70, s52, 20
    s_add_u32 s70, s70, s62
    s_lshl_b32 s71, s52, 15
    buffer_load_dwordx2 v[200:201], v2, s[8:11], 0 offen
    s_mov_b32 m0, s71
    s_add_u32 s71, s71, 1024
    buffer_load_dwordx4 v8, s[16:19], s70 offen lds
    s_add_u32 s70, s70, 0x8000
    s_mov_b32 m0, s71
    s_add_u32 s71, s71, 1024
    buffer_load_dwordx4 v8, s[16:19], s70 offen lds
    s_add_u32 s70, s70, 0x8000
    s_mov_b32 m0, s71
    s_add_u32 s71, s71, 1024
    buffer_load_dwordx4 v9, s[16:19], s70 offen lds
    s_add_u32 s70, s70, 0x8000
    s_mov_b32 m0, s71
    s_add_u32 s71, s71, 1024
    buffer_load_dwordx4 v9, s[16:19], s70 offen lds
    s_add_u32 s70, s70, 0x8000
    s_mov_b32 m0, s71
    s_add_u32 s71, s71, 1024
    buffer_load_dwordx4 v8, s[16:19], s70 offen lds
    s_add_u32 s70, s70, 0x8000
    s_mov_b32 m0, s71
    s_add_u32 s71, s71, 1024
    buffer_load_dwordx4 v8, s[16:19], s70 offen lds
    s_add_u32 s70, s70, 0x8000
    s_mov_b32 m0, s71
    s_add_u32 s71, s71, 1024
    buffer_load_dwordx4 v9, s[16:19], s70 offen lds
    s_add_u32 s70, s70, 0x8000
    s_mov_b32 m0, s71
    s_add_u32 s71, s71, 1024
    buffer_load_dwordx4 v9, s[16:19], s70 offen lds
    s_add_u32 s70, s70, 0x8000
    s_mov_b32 m0, s71
    s_add_u32 s71, s71, 1024
    buffer_load_dwordx4 v8, s[16:19], s70 offen lds
    s_add_u32 s70, s70, 0x8000
    s_mov_b32 m0, s71
    s_add_u32 s71, s71, 1024
    buffer_load_dwordx4 v8, s[16:19], s70 offen lds
    s_add_u32 s70, s70, 0x8000
    s_mov_b32 m0, s71
    s_add_u32 s71, s71, 1024
    buffer_load_dwordx4 v9, s[16:19], s70 offen lds
    s_add_u32 s70, s70, 0x8000
    s_mov_b32 m0, s71
    s_add_u32 s71, s71, 1024
    buffer_load_dwordx4 v9, s[16:19], s70 offen lds
    s_add_u32 s70, s70, 0x8000
    s_mov_b32 m0, s71
    s_add_u32 s71, s71, 1024
    buffer_load_dwordx4 v8, s[16:19], s70 offen lds
    s_add_u32 s70, s70, 0x8000
    s_mov_b32 m0, s71
    s_add_u32 s71, s71, 1024
    buffer_load_dwordx4 v8, s[16:19], s70 offen lds
    s_add_u32 s70, s70, 0x8000
    s_mov_b32 m0, s71
    s_add_u32 s71, s71, 1024
    buffer_load_dwordx4 v9, s[16:19], s70 offen lds
    s_add_u32 s70, s70, 0x8000
    s_mov_b32 m0, s71
    s_add_u32 s71, s71, 1024
    buffer_load_dwordx4 v9, s[16:19], s70 offen lds
    s_add_u32 s70, s70, 0x8000
    s_mov_b32 m0, s71
    s_add_u32 s71, s71, 1024
    buffer_load_dwordx4 v8, s[16:19], s70 offen lds
    s_add_u32 s70, s70, 0x8000
    s_mov_b32 m0, s71
    s_add_u32 s71, s71, 1024
    buffer_load_dwordx4 v8, s[16:19], s70 offen lds
    s_add_u32 s70, s70, 0x8000
    s_mov_b32 m0, s71
    s_add_u32 s71, s71, 1024
    buffer_load_dwordx4 v9, s[16:19], s70 offen lds
    s_add_u32 s70, s70, 0x8000
    s_mov_b32 m0, s71
    s_add_u32 s71, s71, 1024
    buffer_load_dwordx4 v9, s[16:19], s70 offen lds
    s_add_u32 s70, s70, 0x8000
    s_mov_b32 m0, s71
    s_add_u32 s71, s71, 1024
    buffer_load_dwordx4 v8, s[16:19], s70 offen lds
    s_add_u32 s70, s70, 0x8000
    s_mov_b32 m0, s71
    s_add_u32 s71, s71, 1024
    buffer_load_dwordx4 v8, s[16:19], s70 offen lds
    s_add_u32 s70, s70, 0x8000
    s_mov_b32 m0, s71
    s_add_u32 s71, s71, 1024
    buffer_load_dwordx4 v9, s[16:19], s70 offen lds
    s_add_u32 s70, s70, 0x8000
    s_mov_b32 m0, s71
    s_add_u32 s71, s71, 1024
    buffer_load_dwordx4 v9, s[16:19], s70 offen lds
    s_add_u32 s70, s70, 0x8000
    s_mov_b32 m0, s71
    s_add_u32 s71, s71, 1024
    buffer_load_dwordx4 v8, s[16:19], s70 offen lds
    s_add_u32 s70, s70, 0x8000
    s_mov_b32 m0, s71
    s_add_u32 s71, s71, 1024
    buffer_load_dwordx4 v8, s[16:19], s70 offen lds
    s_add_u32 s70, s70, 0x8000
    s_mov_b32 m0, s71
    s_add_u32 s71, s71, 1024
    buffer_load_dwordx4 v9, s[16:19], s70 offen lds
    s_add_u32 s70, s70, 0x8000
    s_mov_b32 m0, s71
    s_add_u32 s71, s71, 1024
    buffer_load_dwordx4 v9, s[16:19], s70 offen lds
    s_add_u32 s70, s70, 0x8000
    s_mov_b32 m0, s71
    s_add_u32 s71, s71, 1024
    buffer_load_dwordx4 v8, s[16:19], s70 offen lds
    s_add_u32 s70, s70, 0x8000
    s_mov_b32 m0, s71
    s_add_u32 s71, s71, 1024
    buffer_load_dwordx4 v8, s[16:19], s70 offen lds
    s_add_u32 s70, s70, 0x8000
    s_mov_b32 m0, s71
    s_add_u32 s71, s71, 1024
    buffer_load_dwordx4 v9, s[16:19], s70 offen lds
    s_add_u32 s70, s70, 0x8000
    s_mov_b32 m0, s71
    s_nop 0
    buffer_load_dwordx4 v9, s[16:19], s70 offen lds
    buffer_load_dwordx4 v[208:211], v10, s[20:23], s63 offen offset:0
    buffer_load_dwordx4 v[212:215], v10, s[20:23], s63 offen offset:64
    buffer_load_dwordx4 v[216:219], v10, s[20:23], s63 offen offset:128
    buffer_load_dwordx4 v[220:223], v10, s[20:23], s63 offen offset:192
    buffer_load_dwordx4 v[224:227], v10, s[20:23], s64 offen offset:0
    buffer_load_dwordx4 v[228:231], v10, s[20:23], s64 offen offset:64
    buffer_load_dwordx4 v[232:235], v10, s[20:23], s64 offen offset:128
    buffer_load_dwordx4 v[236:239], v10, s[20:23], s64 offen offset:192
L_layer:
    s_cmp_eq_u32 s54, 0
    s_cbranch_scc1 L_a_l018
    s_sub_u32 s62, s55, 0x800000
    s_add_u32 s63, s62, 0x38000
    buffer_load_dwordx2 v[8:9], v2, s[48:51], s63 offen sc0 sc1
    s_add_u32 s63, s62, 0x28000
    buffer_load_dwordx4 v[28:31], v3, s[48:51], s63 offen sc0 sc1
    s_add_u32 s63, s62, 0x29000
    buffer_load_dwordx4 v[32:35], v3, s[48:51], s63 offen sc0 sc1
    s_add_u32 s63, s62, 0x2a000
    buffer_load_dwordx4 v[36:39], v3, s[48:51], s63 offen sc0 sc1
    s_add_u32 s63, s62, 0x2b000
    buffer_load_dwordx4 v[40:43], v3, s[48:51], s63 offen sc0 sc1
    s_add_u32 s63, s62, 0x2c000
    buffer_load_dwordx4 v[44:47], v3, s[48:51], s63 offen sc0 sc1
    s_add_u32 s63, s62, 0x2d000
    buffer_load_dwordx4 v[48:51], v3, s[48:51], s63 offen sc0 sc1
    s_add_u32 s63, s62, 0x2e000
    buffer_load_dwordx4 v[52:55], v3, s[48:51], s63 offen sc0 sc1
    s_add_u32 s63, s62, 0x2f000
    buffer_load_dwordx4 v[56:59], v3, s[48:51], s63 offen sc0 sc1
    s_add_u32 s67, s62, 0x39000
    s_waitcnt vmcnt(0)
    v_lshlrev_b32 v12, 16, v8
    v_and_b32 v13, 0xffff0000, v8
    v_lshlrev_b32 v14, 16, v9
    v_and_b32 v15, 0xffff0000, v9
    v_pk_add_f32 v[28:29], v[28:29], v[44:45]
    v_pk_add_f32 v[30:31], v[30:31], v[46:47]
    v_pk_add_f32 v[32:33], v[32:33], v[48:49]
    v_pk_add_f32 v[34:35], v[34:35], v[50:51]
    v_pk_add_f32 v[36:37], v[36:37], v[52:53]
    v_pk_add_f32 v[38:39], v[38:39], v[54:55]
    v_pk_add_f32 v[40:41], v[40:41], v[56:57]
    v_pk_add_f32 v[42:43], v[42:43], v[58:59]
    v_pk_add_f32 v[28:29], v[28:29], v[36:37]
    v_pk_add_f32 v[30:31], v[30:31], v[38:39]
    v_pk_add_f32 v[32:33], v[32:33], v[40:41]
    v_pk_add_f32 v[34:35], v[34:35], v[42:43]
    v_pk_add_f32 v[28:29], v[28:29], v[32:33]
    v_pk_add_f32 v[30:31], v[30:31], v[34:35]
    v_cvt_pk_bf16_f32 v18, v28, v29
    v_cvt_pk_bf16_f32 v19, v30, v31
    v_lshlrev_b32 v28, 16, v18
    v_and_b32 v29, 0xffff0000, v18
    v_lshlrev_b32 v30, 16, v19
    v_and_b32 v31, 0xffff0000, v19
    v_pk_add_f32 v[12:13], v[12:13], v[28:29]
    v_pk_add_f32 v[14:15], v[14:15], v[30:31]
    v_cvt_pk_bf16_f32 v8, v12, v13
    v_cvt_pk_bf16_f32 v9, v14, v15
    v_lshlrev_b32 v12, 16, v8
    v_and_b32 v13, 0xffff0000, v8
    v_lshlrev_b32 v14, 16, v9
    v_and_b32 v15, 0xffff0000, v9
    s_cmp_lg_u32 s2, 128
    s_cbranch_scc1 L_nox20
    buffer_store_dwordx2 v[8:9], v2, s[48:51], s67 offen sc0 sc1
L_nox20:
    s_branch L_a_j19
L_a_l018:
    s_waitcnt vmcnt(40)
    v_mov_b32 v8, v200
    v_mov_b32 v9, v201
L_a_j19:
    v_lshlrev_b32 v12, 16, v8
    v_and_b32 v13, 0xffff0000, v8
    v_lshlrev_b32 v14, 16, v9
    v_and_b32 v15, 0xffff0000, v9
    v_add_f32 v16, v12, v13
    v_add_f32 v18, v14, v15
    v_mul_f32 v17, v12, v12
    v_mul_f32 v19, v14, v14
    v_fmac_f32 v17, v13, v13
    v_fmac_f32 v19, v15, v15
    v_add_f32 v16, v16, v18
    v_add_f32 v17, v17, v19
    s_nop 1
    v_add_f32_dpp v16, v16, v16 quad_perm:[1,0,3,2] row_mask:0xf bank_mask:0xf
    v_add_f32_dpp v17, v17, v17 quad_perm:[1,0,3,2] row_mask:0xf bank_mask:0xf
    s_nop 0
    v_add_f32_dpp v16, v16, v16 quad_perm:[2,3,0,1] row_mask:0xf bank_mask:0xf
    v_add_f32_dpp v17, v17, v17 quad_perm:[2,3,0,1] row_mask:0xf bank_mask:0xf
    s_nop 0
    v_add_f32_dpp v16, v16, v16 row_half_mirror row_mask:0xf bank_mask:0xf
    v_add_f32_dpp v17, v17, v17 row_half_mirror row_mask:0xf bank_mask:0xf
    s_nop 0
    v_add_f32_dpp v16, v16, v16 row_mirror row_mask:0xf bank_mask:0xf
    v_add_f32_dpp v17, v17, v17 row_mirror row_mask:0xf bank_mask:0xf
    s_nop 0
    v_mov_b32 v18, v16
    v_mov_b32 v19, v17
    s_nop 1
    v_permlane16_swap_b32 v16, v18
    v_permlane16_swap_b32 v17, v19
    s_nop 0
    v_add_f32 v16, v16, v18
    v_add_f32 v17, v17, v19
    s_nop 0
    v_mov_b32 v18, v16
    v_mov_b32 v19, v17
    s_nop 1
    v_permlane32_swap_b32 v16, v18
    v_permlane32_swap_b32 v17, v19
    s_nop 0
    v_add_f32 v16, v16, v18
    v_add_f32 v17, v17, v19
    s_nop 0
    s_lshl_b32 s62, s52, 3
    s_add_u32 s62, s62, 137728
    v_mov_b32 v18, s62
    s_and_b32 s63, s52, 2
    s_lshl_b32 s63, s63, 3
    s_add_u32 s63, s63, 137728
    v_mov_b32 v19, s63
    ds_write_b64 v18, v[16:17]
    s_waitcnt lgkmcnt(0)
    s_barrier
    ds_read_b128 v[20:23], v19
    s_waitcnt lgkmcnt(0)
    v_add_f32 v16, v20, v22
    v_add_f32 v17, v21, v23
    v_mul_f32 v16, 0x3b000000, v16
    v_mul_f32 v17, 0x3b000000, v17
    v_fma_f32 v17, -v16, v16, v17
    v_max_f32 v17, 0, v17
    v_cvt_pk_bf16_f32 v17, v17, v17
    v_lshlrev_b32 v17, 16, v17
    v_add_f32 v17, 0x3727c5ac, v17
    v_cvt_pk_bf16_f32 v17, v17, v17
    v_lshlrev_b32 v17, 16, v17
    v_sqrt_f32 v17, v17
    v_cvt_pk_bf16_f32 v16, v16, v16
    v_lshlrev_b32 v16, 16, v16
    v_cvt_pk_bf16_f32 v17, v17, v17
    v_lshlrev_b32 v17, 16, v17
    v_rcp_f32 v17, v17
    v_sub_f32 v12, v12, v16
    v_sub_f32 v13, v13, v16
    v_sub_f32 v14, v14, v16
    v_sub_f32 v15, v15, v16
    v_cvt_pk_bf16_f32 v18, v12, v13
    v_cvt_pk_bf16_f32 v19, v14, v15
    v_lshlrev_b32 v12, 16, v18
    v_and_b32 v13, 0xffff0000, v18
    v_lshlrev_b32 v14, 16, v19
    v_and_b32 v15, 0xffff0000, v19
    v_mul_f32 v12, v12, v17
    v_mul_f32 v13, v13, v17
    v_mul_f32 v14, v14, v17
    v_mul_f32 v15, v15, v17
    v_cvt_pk_bf16_f32 v20, v12, v13
    v_cvt_pk_bf16_f32 v21, v14, v15
    v_add_u32 v18, 131072, v2
    ds_write_b64 v18, v[20:21]
    s_waitcnt lgkmcnt(0)
    s_barrier
    s_lshl_b32 s62, s52, 8
    v_and_b32 v12, 1, v1
    v_mul_u32_u24 v12, 1024, v12
    v_lshrrev_b32 v5, 4, v1
    v_lshl_add_u32 v12, v5, 4, v12
    v_add_u32 v12, 131072, v12
    v_add_u32 v12, s62, v12
    ds_read_b128 v[48:51], v12 offset:0
    ds_read_b128 v[52:55], v12 offset:64
    ds_read_b128 v[56:59], v12 offset:128
    ds_read_b128 v[60:63], v12 offset:192
    s_lshl_b32 s62, s52, 15
    s_cmp_lg_u32 s54, 0
    s_cbranch_scc1 L_ares21
    s_lshl_b32 s62, s52, 15
    v_lshrrev_b32 v5, 4, v1
    v_bfe_u32 v6, v1, 2, 2
    v_lshl_add_u32 v64, v5, 3, v6
    v_lshlrev_b32 v64, 8, v64
    v_and_b32 v5, 1, v5
    v_lshl_add_u32 v5, v5, 2, v6
    v_lshl_add_u32 v64, v5, 5, v64
    v_and_b32 v6, 3, v1
    v_lshl_add_u32 v64, v6, 3, v64
    v_add_u32 v64, s62, v64
    v_xor_b32 v65, 32, v64
    v_xor_b32 v66, 64, v64
    v_xor_b32 v67, 96, v64
    v_xor_b32 v68, 128, v64
    v_xor_b32 v69, 160, v64
    v_xor_b32 v70, 192, v64
    v_xor_b32 v71, 224, v64
    s_waitcnt vmcnt(32)
    ds_read_b64_tr_b16 a[0:1], v64 offset:0
    ds_read_b64_tr_b16 a[2:3], v64 offset:1024
    ds_read_b64_tr_b16 a[4:5], v65 offset:0
    ds_read_b64_tr_b16 a[6:7], v65 offset:1024
    ds_read_b64_tr_b16 a[8:9], v66 offset:0
    ds_read_b64_tr_b16 a[10:11], v66 offset:1024
    ds_read_b64_tr_b16 a[12:13], v67 offset:0
    ds_read_b64_tr_b16 a[14:15], v67 offset:1024
    ds_read_b64_tr_b16 a[16:17], v68 offset:0
    ds_read_b64_tr_b16 a[18:19], v68 offset:1024
    ds_read_b64_tr_b16 a[20:21], v69 offset:0
    ds_read_b64_tr_b16 a[22:23], v69 offset:1024
    s_waitcnt lgkmcnt(10)
    ds_read_b64_tr_b16 a[24:25], v70 offset:0
    ds_read_b64_tr_b16 a[26:27], v70 offset:1024
    s_waitcnt lgkmcnt(10)
    ds_read_b64_tr_b16 a[28:29], v71 offset:0
    ds_read_b64_tr_b16 a[30:31], v71 offset:1024
    s_waitcnt lgkmcnt(0)
    s_waitcnt vmcnt(24)
    ds_read_b64_tr_b16 a[32:33], v64 offset:8192
    ds_read_b64_tr_b16 a[34:35], v64 offset:9216
    ds_read_b64_tr_b16 a[36:37], v65 offset:8192
    ds_read_b64_tr_b16 a[38:39], v65 offset:9216
    ds_read_b64_tr_b16 a[40:41], v66 offset:8192
    ds_read_b64_tr_b16 a[42:43], v66 offset:9216
    ds_read_b64_tr_b16 a[44:45], v67 offset:8192
    ds_read_b64_tr_b16 a[46:47], v67 offset:9216
    ds_read_b64_tr_b16 a[48:49], v68 offset:8192
    ds_read_b64_tr_b16 a[50:51], v68 offset:9216
    ds_read_b64_tr_b16 a[52:53], v69 offset:8192
    ds_read_b64_tr_b16 a[54:55], v69 offset:9216
    s_waitcnt lgkmcnt(10)
    ds_read_b64_tr_b16 a[56:57], v70 offset:8192
    ds_read_b64_tr_b16 a[58:59], v70 offset:9216
    s_waitcnt lgkmcnt(10)
    ds_read_b64_tr_b16 a[60:61], v71 offset:8192
    ds_read_b64_tr_b16 a[62:63], v71 offset:9216
    s_waitcnt lgkmcnt(0)
    s_waitcnt vmcnt(16)
    ds_read_b64_tr_b16 a[64:65], v64 offset:16384
    ds_read_b64_tr_b16 a[66:67], v64 offset:17408
    ds_read_b64_tr_b16 a[68:69], v65 offset:16384
    ds_read_b64_tr_b16 a[70:71], v65 offset:17408
    ds_read_b64_tr_b16 a[72:73], v66 offset:16384
    ds_read_b64_tr_b16 a[74:75], v66 offset:17408
    ds_read_b64_tr_b16 a[76:77], v67 offset:16384
    ds_read_b64_tr_b16 a[78:79], v67 offset:17408
    ds_read_b64_tr_b16 a[80:81], v68 offset:16384
    ds_read_b64_tr_b16 a[82:83], v68 offset:17408
    ds_read_b64_tr_b16 a[84:85], v69 offset:16384
    ds_read_b64_tr_b16 a[86:87], v69 offset:17408
    s_waitcnt lgkmcnt(10)
    ds_read_b64_tr_b16 a[88:89], v70 offset:16384
    ds_read_b64_tr_b16 a[90:91], v70 offset:17408
    s_waitcnt lgkmcnt(10)
    ds_read_b64_tr_b16 a[92:93], v71 offset:16384
    ds_read_b64_tr_b16 a[94:95], v71 offset:17408
    s_waitcnt lgkmcnt(0)
    s_waitcnt vmcnt(8)
    ds_read_b64_tr_b16 a[96:97], v64 offset:24576
    ds_read_b64_tr_b16 a[98:99], v64 offset:25600
    ds_read_b64_tr_b16 a[100:101], v65 offset:24576
    ds_read_b64_tr_b16 a[102:103], v65 offset:25600
    ds_read_b64_tr_b16 a[104:105], v66 offset:24576
    ds_read_b64_tr_b16 a[106:107], v66 offset:25600
    ds_read_b64_tr_b16 a[108:109], v67 offset:24576
    ds_read_b64_tr_b16 a[110:111], v67 offset:25600
    ds_read_b64_tr_b16 a[112:113], v68 offset:24576
    ds_read_b64_tr_b16 a[114:115], v68 offset:25600
    ds_read_b64_tr_b16 a[116:117], v69 offset:24576
    ds_read_b64_tr_b16 a[118:119], v69 offset:25600
    s_waitcnt lgkmcnt(10)
    ds_read_b64_tr_b16 a[120:121], v70 offset:24576
    ds_read_b64_tr_b16 a[122:123], v70 offset:25600
    s_waitcnt lgkmcnt(10)
    ds_read_b64_tr_b16 a[124:125], v71 offset:24576
    ds_read_b64_tr_b16 a[126:127], v71 offset:25600
    s_waitcnt lgkmcnt(0)
    s_mov_b32 s62, 0x1000000
    v_mov_b32 v5, 0
    buffer_load_dword v202, v5, s[48:51], s62 offen sc0 sc1
L_ares21:
    s_waitcnt lgkmcnt(0)
    v_mfma_f32_16x16x32_bf16 v[72:75], a[0:3], v[48:51], 0
    v_mfma_f32_16x16x32_bf16 v[76:79], a[4:7], v[48:51], 0
    v_mfma_f32_16x16x32_bf16 v[80:83], a[8:11], v[48:51], 0
    v_mfma_f32_16x16x32_bf16 v[84:87], a[12:15], v[48:51], 0
    v_mfma_f32_16x16x32_bf16 v[88:91], a[16:19], v[48:51], 0
    v_mfma_f32_16x16x32_bf16 v[92:95], a[20:23], v[48:51], 0
    v_mfma_f32_16x16x32_bf16 v[96:99], a[24:27], v[48:51], 0
    v_mfma_f32_16x16x32_bf16 v[100:103], a[28:31], v[48:51], 0
    v_mfma_f32_16x16x32_bf16 v[72:75], a[32:35], v[52:55], v[72:75]
    v_mfma_f32_16x16x32_bf16 v[76:79], a[36:39], v[52:55], v[76:79]
    v_mfma_f32_16x16x32_bf16 v[80:83], a[40:43], v[52:55], v[80:83]
    v_mfma_f32_16x16x32_bf16 v[84:87], a[44:47], v[52:55], v[84:87]
    v_mfma_f32_16x16x32_bf16 v[88:91], a[48:51], v[52:55], v[88:91]
    v_mfma_f32_16x16x32_bf16 v[92:95], a[52:55], v[52:55], v[92:95]
    v_mfma_f32_16x16x32_bf16 v[96:99], a[56:59], v[52:55], v[96:99]
    v_mfma_f32_16x16x32_bf16 v[100:103], a[60:63], v[52:55], v[100:103]
    v_mfma_f32_16x16x32_bf16 v[72:75], a[64:67], v[56:59], v[72:75]
    v_mfma_f32_16x16x32_bf16 v[76:79], a[68:71], v[56:59], v[76:79]
    v_mfma_f32_16x16x32_bf16 v[80:83], a[72:75], v[56:59], v[80:83]
    v_mfma_f32_16x16x32_bf16 v[84:87], a[76:79], v[56:59], v[84:87]
    v_mfma_f32_16x16x32_bf16 v[88:91], a[80:83], v[56:59], v[88:91]
    v_mfma_f32_16x16x32_bf16 v[92:95], a[84:87], v[56:59], v[92:95]
    v_mfma_f32_16x16x32_bf16 v[96:99], a[88:91], v[56:59], v[96:99]
    v_mfma_f32_16x16x32_bf16 v[100:103], a[92:95], v[56:59], v[100:103]
    v_mfma_f32_16x16x32_bf16 v[72:75], a[96:99], v[60:63], v[72:75]
    v_mfma_f32_16x16x32_bf16 v[76:79], a[100:103], v[60:63], v[76:79]
    v_mfma_f32_16x16x32_bf16 v[80:83], a[104:107], v[60:63], v[80:83]
    v_mfma_f32_16x16x32_bf16 v[84:87], a[108:111], v[60:63], v[84:87]
    v_mfma_f32_16x16x32_bf16 v[88:91], a[112:115], v[60:63], v[88:91]
    v_mfma_f32_16x16x32_bf16 v[92:95], a[116:119], v[60:63], v[92:95]
    v_mfma_f32_16x16x32_bf16 v[96:99], a[120:123], v[60:63], v[96:99]
    v_mfma_f32_16x16x32_bf16 v[100:103], a[124:127], v[60:63], v[100:103]
    v_and_b32 v6, 15, v1
    v_lshrrev_b32 v5, 4, v1
    v_lshlrev_b32 v12, 9, v6
    v_lshl_add_u32 v12, v5, 4, v12
    s_lshl_b32 s62, s52, 10
    s_add_u32 s62, s62, 133120
    v_add_u32 v12, s62, v12
    v_cmp_gt_u32 vcc, 2, v6
    s_and_saveexec_b64 s[72:73], vcc
    s_nop 4
    ds_write_b128 v12, v[72:75] offset:0
    ds_write_b128 v12, v[76:79] offset:64
    ds_write_b128 v12, v[80:83] offset:128
    ds_write_b128 v12, v[84:87] offset:192
    ds_write_b128 v12, v[88:91] offset:256
    ds_write_b128 v12, v[92:95] offset:320
    ds_write_b128 v12, v[96:99] offset:384
    ds_write_b128 v12, v[100:103] offset:448
    s_mov_b64 exec, s[72:73]
    v_lshlrev_b32 v12, 2, v0
    v_add_u32 v12, 133120, v12
    s_waitcnt lgkmcnt(0)
    s_barrier
    ds_read_b32 v14, v12
    ds_read_b32 v15, v12 offset:1024
    ds_read_b32 v16, v12 offset:2048
    ds_read_b32 v17, v12 offset:3072
    v_lshlrev_b32 v12, 1, v0
    v_add_u32 v12, 137216, v12
    s_waitcnt lgkmcnt(0)
    v_add_f32 v14, v14, v15
    v_add_f32 v16, v16, v17
    v_add_f32 v14, v14, v16
    v_cvt_pk_bf16_f32 v14, v14, v14
    ds_write_b16 v12, v14
    v_and_b32 v12, 1, v1
    v_mul_u32_u24 v12, 256, v12
    v_lshrrev_b32 v5, 4, v1
    v_lshl_add_u32 v12, v5, 4, v12
    v_add_u32 v12, 137216, v12
    s_waitcnt lgkmcnt(0)
    s_barrier
    ds_read_b128 v[48:51], v12 offset:0
    ds_read_b128 v[52:55], v12 offset:64
    ds_read_b128 v[56:59], v12 offset:128
    ds_read_b128 v[60:63], v12 offset:192
    v_lshrrev_b32 v5, 4, v1
    v_lshlrev_b32 v12, 15, v6
    v_lshl_add_u32 v12, v5, 3, v12
    s_lshl_b32 s62, s56, 10
    s_and_b32 s63, s57, 3
    s_lshl_b32 s63, s63, 8
    s_add_u32 s62, s62, s63
    s_lshl_b32 s63, s52, 6
    s_add_u32 s62, s62, s63
    s_add_u32 s62, s62, s55
    s_waitcnt vmcnt(0) lgkmcnt(0)
    v_mfma_f32_16x16x32_bf16 v[72:75], v[208:211], v[48:51], 0
    v_mfma_f32_16x16x32_bf16 v[76:79], v[224:227], v[48:51], 0
    v_mfma_f32_16x16x32_bf16 v[72:75], v[212:215], v[52:55], v[72:75]
    v_mfma_f32_16x16x32_bf16 v[76:79], v[228:231], v[52:55], v[76:79]
    v_mfma_f32_16x16x32_bf16 v[72:75], v[216:219], v[56:59], v[72:75]
    v_mfma_f32_16x16x32_bf16 v[76:79], v[232:235], v[56:59], v[76:79]
    v_mfma_f32_16x16x32_bf16 v[72:75], v[220:223], v[60:63], v[72:75]
    v_mfma_f32_16x16x32_bf16 v[76:79], v[236:239], v[60:63], v[76:79]
    s_nop 7
    v_cvt_pk_bf16_f32 v72, v72, v73
    v_cvt_pk_bf16_f32 v73, v74, v75
    v_cvt_pk_bf16_f32 v74, v76, v77
    v_cvt_pk_bf16_f32 v75, v78, v79
    v_cmp_gt_u32 vcc, 2, v6
    s_and_saveexec_b64 s[72:73], vcc
    buffer_store_dwordx2 v[72:73], v12, s[48:51], s62 offen sc0 sc1
    buffer_store_dwordx2 v[74:75], v12, s[48:51], s62 offen offset:32 sc0 sc1
    s_mov_b64 exec, s[72:73]
    s_cmp_lg_u32 s54, 0
    s_cbranch_scc1 L_zok22
    v_cmp_ne_u32 vcc, s53, v202
    s_cbranch_vccz L_zok22
    s_cmp_lg_u32 s52, 0
    s_cbranch_scc1 L_zc23
    s_mov_b32 s63, 400000
    s_mov_b32 s62, 0x1000000
    v_mov_b32 v5, 0
L_zl24:
    buffer_load_dword v6, v5, s[48:51], s62 offen sc0 sc1
    s_waitcnt vmcnt(0)
    v_cmp_ne_u32 vcc, s53, v6
    s_cbranch_vccz L_zc23
    s_sub_u32 s63, s63, 1
    s_cmp_lg_u32 s63, 0
    s_cbranch_scc1 L_zl24
L_zc23:
L_zok22:
    s_waitcnt vmcnt(0)
    s_barrier
    s_cmp_lg_u32 s52, 0
    s_cbranch_scc1 L_pub25
    v_lshlrev_b32 v6, 12, v1
    s_mov_b64 s[72:73], exec
    s_mov_b64 exec, 1
    s_mov_b64 exec, 0xff
    s_lshl_b32 s62, s54, 17
    s_and_b32 s63, s2, 15
    s_lshl_b32 s63, s63, 8
    s_add_u32 s62, s62, s63
    s_add_u32 s62, s62, 0x1200000
    v_mov_b32 v5, 1
    buffer_atomic_add v5, v6, s[48:51], s62 offen sc1
    s_mov_b64 exec, s[72:73]
L_pub25:
    s_cmp_lg_u32 s54, 0
    s_cbranch_scc1 L_c127
    v_lshrrev_b32 v5, 2, v1
    v_and_b32 v6, 3, v1
    v_bfe_u32 v7, v5, 3, 1
    v_lshlrev_b32 v7, 1, v7
    v_xor_b32 v6, v6, v7
    v_lshlrev_b32 v6, 4, v6
    v_lshl_add_u32 v8, v5, 13, v6
    v_lshrrev_b32 v5, 3, v1
    v_and_b32 v6, 7, v1
    v_and_b32 v7, 2, v5
    v_xor_b32 v6, v6, v7
    v_lshlrev_b32 v6, 4, v6
    v_lshl_add_u32 v9, v5, 10, v6
    v_xor_b32 v10, 0x40, v9
    s_lshl_b32 s70, s58, 20
    s_lshl_b32 s62, s56, 8
    s_add_u32 s70, s70, s62
    s_lshl_b32 s62, s52, 6
    s_add_u32 s70, s70, s62
    s_lshl_b32 s71, s52, 13
    s_add_u32 s71, s71, 65536
    s_mov_b32 m0, s71
    s_add_u32 s71, s71, 1024
    buffer_load_dwordx4 v8, s[24:27], s70 offen lds
    s_add_u32 s70, s70, 0x20000
    s_mov_b32 m0, s71
    s_add_u32 s71, s71, 1024
    buffer_load_dwordx4 v8, s[24:27], s70 offen lds
    s_add_u32 s70, s70, 0x20000
    s_mov_b32 m0, s71
    s_add_u32 s71, s71, 1024
    buffer_load_dwordx4 v8, s[24:27], s70 offen lds
    s_add_u32 s70, s70, 0x20000
    s_mov_b32 m0, s71
    s_add_u32 s71, s71, 1024
    buffer_load_dwordx4 v8, s[24:27], s70 offen lds
    s_add_u32 s70, s70, 0x20000
    s_mov_b32 m0, s71
    s_add_u32 s71, s71, 1024
    buffer_load_dwordx4 v8, s[24:27], s70 offen lds
    s_add_u32 s70, s70, 0x20000
    s_mov_b32 m0, s71
    s_add_u32 s71, s71, 1024
    buffer_load_dwordx4 v8, s[24:27], s70 offen lds
    s_add_u32 s70, s70, 0x20000
    s_mov_b32 m0, s71
    s_add_u32 s71, s71, 1024
    buffer_load_dwordx4 v8, s[24:27], s70 offen lds
    s_add_u32 s70, s70, 0x20000
    s_mov_b32 m0, s71
    s_nop 0
    buffer_load_dwordx4 v8, s[24:27], s70 offen lds
    s_lshl_b32 s70, s56, 17
    s_lshl_b32 s62, s59, 9
    s_add_u32 s70, s70, s62
    s_lshl_b32 s62, s52, 7
    s_add_u32 s70, s70, s62
    s_add_u32 s70, s70, 0
    s_mul_i32 s71, s52, 16384
    s_add_u32 s71, s71, 0
    s_mov_b32 m0, s71
    s_add_u32 s71, s71, 1024
    buffer_load_dwordx4 v9, s[28:31], s70 offen lds
    s_add_u32 s70, s70, 0x2000
    s_mov_b32 m0, s71
    s_add_u32 s71, s71, 1024
    buffer_load_dwordx4 v10, s[28:31], s70 offen lds
    s_add_u32 s70, s70, 0x2000
    s_mov_b32 m0, s71
    s_add_u32 s71, s71, 1024
    buffer_load_dwordx4 v9, s[28:31], s70 offen lds
    s_add_u32 s70, s70, 0x2000
    s_mov_b32 m0, s71
    s_add_u32 s71, s71, 1024
    buffer_load_dwordx4 v10, s[28:31], s70 offen lds
    s_add_u32 s70, s70, 0x2000
    s_mov_b32 m0, s71
    s_add_u32 s71, s71, 1024
    buffer_load_dwordx4 v9, s[28:31], s70 offen lds
    s_add_u32 s70, s70, 0x2000
    s_mov_b32 m0, s71
    s_add_u32 s71, s71, 1024
    buffer_load_dwordx4 v10, s[28:31], s70 offen lds
    s_add_u32 s70, s70, 0x2000
    s_mov_b32 m0, s71
    s_add_u32 s71, s71, 1024
    buffer_load_dwordx4 v9, s[28:31], s70 offen lds
    s_add_u32 s70, s70, 0x2000
    s_mov_b32 m0, s71
    s_add_u32 s71, s71, 1024
    buffer_load_dwordx4 v10, s[28:31], s70 offen lds
    s_add_u32 s70, s70, 0x2000
    s_mov_b32 m0, s71
    s_add_u32 s71, s71, 1024
    buffer_load_dwordx4 v9, s[28:31], s70 offen lds
    s_add_u32 s70, s70, 0x2000
    s_mov_b32 m0, s71
    s_add_u32 s71, s71, 1024
    buffer_load_dwordx4 v10, s[28:31], s70 offen lds
    s_add_u32 s70, s70, 0x2000
    s_mov_b32 m0, s71
    s_add_u32 s71, s71, 1024
    buffer_load_dwordx4 v9, s[28:31], s70 offen lds
    s_add_u32 s70, s70, 0x2000
    s_mov_b32 m0, s71
    s_add_u32 s71, s71, 1024
    buffer_load_dwordx4 v10, s[28:31], s70 offen lds
    s_add_u32 s70, s70, 0x2000
    s_mov_b32 m0, s71
    s_add_u32 s71, s71, 1024
    buffer_load_dwordx4 v9, s[28:31], s70 offen lds
    s_add_u32 s70, s70, 0x2000
    s_mov_b32 m0, s71
    s_add_u32 s71, s71, 1024
    buffer_load_dwordx4 v10, s[28:31], s70 offen lds
    s_add_u32 s70, s70, 0x2000
    s_mov_b32 m0, s71
    s_add_u32 s71, s71, 1024
    buffer_load_dwordx4 v9, s[28:31], s70 offen lds
    s_add_u32 s70, s70, 0x2000
    s_mov_b32 m0, s71
    s_nop 0
    buffer_load_dwordx4 v10, s[28:31], s70 offen lds
    s_cmp_eq_u32 s61, 0
    s_cbranch_scc1 L_nds28
    v_lshrrev_b32 v5, 1, v1
    v_bfe_u32 v6, v1, 4, 1
    v_lshlrev_b32 v6, 2, v6
    v_xor_b32 v5, v5, v6
    v_and_b32 v6, 1, v1
    v_lshlrev_b32 v6, 4, v6
    v_mul_u32_u24 v20, 3584, v5
    v_add_u32 v20, v20, v6
    v_lshrrev_b32 v5, 4, v1
    v_and_b32 v6, 15, v1
    v_lshlrev_b32 v7, 1, v5
    v_xor_b32 v6, v6, v7
    v_lshlrev_b32 v6, 4, v6
    v_lshl_add_u32 v21, v5, 10, v6
    v_xor_b32 v22, 0x80, v21
    s_mul_i32 s70, s52, 458752
    s_lshl_b32 s62, s60, 5
    s_add_u32 s70, s70, s62
    s_lshl_b32 s71, s52, 12
    s_add_u32 s71, s71, 98304
    s_mov_b32 m0, s71
    s_add_u32 s63, s71, 16384
    buffer_load_dwordx4 v20, s[32:35], s70 offen lds
    s_mov_b32 m0, s63
    s_add_u32 s71, s71, 1024
    buffer_load_dwordx4 v20, s[36:39], s70 offen lds
    s_add_u32 s70, s70, 114688
    s_mov_b32 m0, s71
    s_add_u32 s63, s71, 16384
    buffer_load_dwordx4 v20, s[32:35], s70 offen lds
    s_mov_b32 m0, s63
    s_add_u32 s71, s71, 1024
    buffer_load_dwordx4 v20, s[36:39], s70 offen lds
    s_add_u32 s70, s70, 114688
    s_mov_b32 m0, s71
    s_add_u32 s63, s71, 16384
    buffer_load_dwordx4 v20, s[32:35], s70 offen lds
    s_mov_b32 m0, s63
    s_add_u32 s71, s71, 1024
    buffer_load_dwordx4 v20, s[36:39], s70 offen lds
    s_add_u32 s70, s70, 114688
    s_mov_b32 m0, s71
    s_add_u32 s63, s71, 16384
    buffer_load_dwordx4 v20, s[32:35], s70 offen lds
    s_mov_b32 m0, s63
    s_add_u32 s71, s71, 1024
    buffer_load_dwordx4 v20, s[36:39], s70 offen lds
    s_add_u32 s70, s70, 114688
    s_lshl_b32 s70, s60, 14
    s_lshl_b32 s62, s52, 8
    s_add_u32 s70, s70, s62
    s_lshl_b32 s71, s52, 12
    s_add_u32 s71, s71, 131072
    s_mov_b32 m0, s71
    s_add_u32 s71, s71, 1024
    buffer_load_dwordx4 v21, s[40:43], s70 offen lds
    s_add_u32 s70, s70, 0x1000
    s_mov_b32 m0, s71
    s_add_u32 s71, s71, 1024
    buffer_load_dwordx4 v22, s[40:43], s70 offen lds
    s_add_u32 s70, s70, 0x1000
    s_mov_b32 m0, s71
    s_add_u32 s71, s71, 1024
    buffer_load_dwordx4 v21, s[40:43], s70 offen lds
    s_add_u32 s70, s70, 0x1000
    s_mov_b32 m0, s71
    s_nop 0
    buffer_load_dwordx4 v22, s[40:43], s70 offen lds
L_nds28:
    s_waitcnt vmcnt(0)
    s_lshl_b32 s64, s52, 13
    s_add_u32 s64, s64, 65536
    v_lshrrev_b32 v5, 4, v1
    v_bfe_u32 v6, v1, 2, 2
    v_lshl_add_u32 v12, v5, 3, v6
    v_lshlrev_b32 v12, 6, v12
    v_and_b32 v5, 1, v5
    v_lshl_add_u32 v12, v5, 5, v12
    v_and_b32 v6, 3, v1
    v_lshl_add_u32 v12, v6, 3, v12
    v_add_u32 v12, s64, v12
    v_xor_b32 v13, 32, v12
    ds_read_b64_tr_b16 a[128:129], v12 offset:0
    ds_read_b64_tr_b16 a[130:131], v12 offset:256
    ds_read_b64_tr_b16 a[132:133], v13 offset:0
    ds_read_b64_tr_b16 a[134:135], v13 offset:256
    ds_read_b64_tr_b16 a[136:137], v12 offset:2048
    ds_read_b64_tr_b16 a[138:139], v12 offset:2304
    ds_read_b64_tr_b16 a[140:141], v13 offset:2048
    ds_read_b64_tr_b16 a[142:143], v13 offset:2304
    ds_read_b64_tr_b16 a[144:145], v12 offset:4096
    ds_read_b64_tr_b16 a[146:147], v12 offset:4352
    ds_read_b64_tr_b16 a[148:149], v13 offset:4096
    ds_read_b64_tr_b16 a[150:151], v13 offset:4352
    s_waitcnt lgkmcnt(10)
    ds_read_b64_tr_b16 a[152:153], v12 offset:6144
    ds_read_b64_tr_b16 a[154:155], v12 offset:6400
    s_waitcnt lgkmcnt(10)
    ds_read_b64_tr_b16 a[156:157], v13 offset:6144
    ds_read_b64_tr_b16 a[158:159], v13 offset:6400
    s_waitcnt lgkmcnt(0)
    s_mul_i32 s64, s52, 16384
    s_add_u32 s64, s64, 0
    v_lshrrev_b32 v5, 4, v1
    v_bfe_u32 v6, v1, 2, 2
    v_lshl_add_u32 v12, v5, 3, v6
    v_lshlrev_b32 v12, 7, v12
    v_and_b32 v5, 1, v5
    v_lshrrev_b32 v6, 1, v6
    v_lshl_add_u32 v5, v5, 1, v6
    v_lshl_add_u32 v12, v5, 5, v12
    v_and_b32 v6, 3, v1
    v_lshl_add_u32 v12, v6, 3, v12
    v_add_u32 v12, s64, v12
    v_xor_b32 v13, 32, v12
    v_xor_b32 v14, 64, v12
    v_xor_b32 v15, 96, v12
    ds_read_b64_tr_b16 a[160:161], v12 offset:0
    ds_read_b64_tr_b16 a[162:163], v12 offset:512
    ds_read_b64_tr_b16 a[164:165], v13 offset:0
    ds_read_b64_tr_b16 a[166:167], v13 offset:512
    ds_read_b64_tr_b16 a[168:169], v14 offset:0
    ds_read_b64_tr_b16 a[170:171], v14 offset:512
    ds_read_b64_tr_b16 a[172:173], v15 offset:0
    ds_read_b64_tr_b16 a[174:175], v15 offset:512
    ds_read_b64_tr_b16 a[176:177], v12 offset:4096
    ds_read_b64_tr_b16 a[178:179], v12 offset:4608
    ds_read_b64_tr_b16 a[180:181], v13 offset:4096
    ds_read_b64_tr_b16 a[182:183], v13 offset:4608
    s_waitcnt lgkmcnt(10)
    ds_read_b64_tr_b16 a[184:185], v14 offset:4096
    ds_read_b64_tr_b16 a[186:187], v14 offset:4608
    s_waitcnt lgkmcnt(10)
    ds_read_b64_tr_b16 a[188:189], v15 offset:4096
    ds_read_b64_tr_b16 a[190:191], v15 offset:4608
    s_waitcnt lgkmcnt(10)
    ds_read_b64_tr_b16 a[192:193], v12 offset:8192
    ds_read_b64_tr_b16 a[194:195], v12 offset:8704
    s_waitcnt lgkmcnt(10)
    ds_read_b64_tr_b16 a[196:197], v13 offset:8192
    ds_read_b64_tr_b16 a[198:199], v13 offset:8704
    s_waitcnt lgkmcnt(10)
    ds_read_b64_tr_b16 a[200:201], v14 offset:8192
    ds_read_b64_tr_b16 a[202:203], v14 offset:8704
    s_waitcnt lgkmcnt(10)
    ds_read_b64_tr_b16 a[204:205], v15 offset:8192
    ds_read_b64_tr_b16 a[206:207], v15 offset:8704
    s_waitcnt lgkmcnt(10)
    ds_read_b64_tr_b16 a[208:209], v12 offset:12288
    ds_read_b64_tr_b16 a[210:211], v12 offset:12800
    s_waitcnt lgkmcnt(10)
    ds_read_b64_tr_b16 a[212:213], v13 offset:12288
    ds_read_b64_tr_b16 a[214:215], v13 offset:12800
    s_waitcnt lgkmcnt(10)
    ds_read_b64_tr_b16 a[216:217], v14 offset:12288
    ds_read_b64_tr_b16 a[218:219], v14 offset:12800
    s_waitcnt lgkmcnt(10)
    ds_read_b64_tr_b16 a[220:221], v15 offset:12288
    ds_read_b64_tr_b16 a[222:223], v15 offset:12800
    s_waitcnt lgkmcnt(0)
    s_cmp_eq_u32 s61, 0
    s_cbranch_scc1 L_nds29
    s_lshl_b32 s62, s52, 12
    s_add_u32 s63, s62, 98304
    v_lshrrev_b32 v5, 4, v1
    v_and_b32 v6, 1, v5
    v_lshlrev_b32 v6, 2, v6
    v_lshl_add_u32 v5, v5, 3, v6
    v_bfe_u32 v6, v1, 2, 2
    v_add_u32 v5, v5, v6
    v_lshlrev_b32 v5, 5, v5
    v_and_b32 v6, 3, v1
    v_lshl_add_u32 v5, v6, 3, v5
    v_add_u32 v20, s63, v5
    v_xor_b32 v21, 0x80, v20
    s_add_u32 s62, s62, 131072
    v_lshrrev_b32 v5, 4, v1
    v_bfe_u32 v6, v1, 2, 2
    v_lshl_add_u32 v22, v5, 2, v6
    v_lshlrev_b32 v22, 8, v22
    v_and_b32 v5, 1, v5
    v_lshl_add_u32 v5, v5, 2, v6
    v_lshl_add_u32 v22, v5, 5, v22
    v_and_b32 v6, 3, v1
    v_lshl_add_u32 v22, v6, 3, v22
    v_add_u32 v22, s62, v22
    v_xor_b32 v23, 32, v22
    v_xor_b32 v24, 64, v22
    v_xor_b32 v25, 96, v22
    v_xor_b32 v26, 128, v22
    v_xor_b32 v27, 160, v22
    v_xor_b32 v28, 192, v22
    v_xor_b32 v29, 224, v22
    ds_read_b64_tr_b16 a[224:225], v20 offset:0
    ds_read_b64_tr_b16 a[226:227], v21 offset:0
    ds_read_b64_tr_b16 a[228:229], v20 offset:1024
    ds_read_b64_tr_b16 a[230:231], v21 offset:1024
    ds_read_b64_tr_b16 a[232:233], v20 offset:2048
    ds_read_b64_tr_b16 a[234:235], v21 offset:2048
    ds_read_b64_tr_b16 a[236:237], v20 offset:3072
    ds_read_b64_tr_b16 a[238:239], v21 offset:3072
    ds_read_b64_tr_b16 a[240:241], v20 offset:16384
    ds_read_b64_tr_b16 a[242:243], v21 offset:16384
    ds_read_b64_tr_b16 a[244:245], v20 offset:17408
    ds_read_b64_tr_b16 a[246:247], v21 offset:17408
    ds_read_b64_tr_b16 a[248:249], v20 offset:18432
    ds_read_b64_tr_b16 a[250:251], v21 offset:18432
    ds_read_b64_tr_b16 a[252:253], v20 offset:19456
    ds_read_b64_tr_b16 a[254:255], v21 offset:19456
    s_waitcnt lgkmcnt(6)
    ds_read_b64_tr_b16 v[240:241], v22
    ds_read_b64_tr_b16 v[242:243], v23
    ds_read_b64_tr_b16 v[244:245], v24
    ds_read_b64_tr_b16 v[246:247], v25
    ds_read_b64_tr_b16 v[248:249], v26
    ds_read_b64_tr_b16 v[250:251], v27
    ds_read_b64_tr_b16 v[252:253], v28
    ds_read_b64_tr_b16 v[254:255], v29
    s_waitcnt lgkmcnt(0)
L_nds29:
L_c127:
    s_cmp_lg_u32 s52, 0
    s_cbranch_scc1 L_wf30
    s_mov_b32 s63, 400000
    s_sub_u32 s62, s54, 0
    s_lshl_b32 s62, s62, 17
    s_add_u32 s62, s62, 0x1208000
    s_and_b32 s64, s2, 7
    s_lshl_b32 s64, s64, 12
    s_add_u32 s62, s62, s64
    v_and_b32 v5, 15, v1
    v_mov_b32 v6, 8
    v_lshlrev_b32 v5, 8, v5
L_poll31:
    buffer_load_dword v196, v5, s[48:51], s62 offen sc0 sc1
    s_waitcnt vmcnt(0)
    v_cmp_ne_u32 vcc, v6, v196
    s_cbranch_vccz L_pdone32
    s_sub_u32 s63, s63, 1
    s_cmp_lg_u32 s63, 0
    s_cbranch_scc1 L_poll31
L_pdone32:
L_wf30:
    s_barrier
    v_lshrrev_b32 v5, 2, v1
    v_and_b32 v6, 3, v1
    v_bfe_u32 v7, v5, 3, 1
    v_lshlrev_b32 v7, 1, v7
    v_xor_b32 v6, v6, v7
    v_lshlrev_b32 v6, 4, v6
    v_lshl_add_u32 v8, v5, 15, v6
    v_lshlrev_b32 v5, 3, v1
    s_lshl_b32 s62, s56, 9
    s_add_u32 s62, s62, 0x10000
    s_add_u32 s62, s62, s55
    buffer_load_dwordx2 v[10:11], v5, s[48:51], s62 offen sc0 sc1
    s_add_u32 s62, s62, 0x4000
    buffer_load_dwordx2 v[12:13], v5, s[48:51], s62 offen sc0 sc1
    s_lshl_b32 s70, s56, 8
    s_lshl_b32 s62, s58, 6
    s_add_u32 s70, s70, s62
    s_lshl_b32 s62, s52, 13
    s_add_u32 s70, s70, s62
    s_add_u32 s70, s70, 0x100000
    s_add_u32 s70, s70, s55
    buffer_load_dwordx4 v[112:115], v8, s[48:51], s70 offen sc0 sc1
    s_add_u32 s70, s70, 0x80000
    buffer_load_dwordx4 v[116:119], v8, s[48:51], s70 offen sc0 sc1
    s_add_u32 s70, s70, 0x80000
    buffer_load_dwordx4 v[120:123], v8, s[48:51], s70 offen sc0 sc1
    s_add_u32 s70, s70, 0x80000
    buffer_load_dwordx4 v[124:127], v8, s[48:51], s70 offen sc0 sc1
    s_add_u32 s70, s70, 0x80000
    buffer_load_dwordx4 v[128:131], v8, s[48:51], s70 offen sc0 sc1
    s_add_u32 s70, s70, 0x80000
    buffer_load_dwordx4 v[132:135], v8, s[48:51], s70 offen sc0 sc1
    s_add_u32 s70, s70, 0x80000
    buffer_load_dwordx4 v[136:139], v8, s[48:51], s70 offen sc0 sc1
    s_add_u32 s70, s70, 0x80000
    buffer_load_dwordx4 v[140:143], v8, s[48:51], s70 offen sc0 sc1
    s_lshl_b32 s68, s52, 9
    s_add_u32 s68, s68, 147456
    v_mov_b32 v18, 0
    v_lshlrev_b32 v5, 1, v1
    v_add_u32 v30, s68, v5
    ds_write_b16 v30, v18 offset:256
    s_lshl_b32 s64, s52, 12
    s_add_u32 s64, s64, 131072
    v_add_u32 v31, s64, v4
    v_lshrrev_b32 v5, 4, v1
    v_bfe_u32 v6, v1, 2, 2
    v_lshl_add_u32 v20, v5, 3, v6
    v_lshlrev_b32 v20, 6, v20
    v_and_b32 v5, 1, v5
    v_lshl_add_u32 v20, v5, 5, v20
    v_and_b32 v6, 3, v1
    v_lshl_add_u32 v20, v6, 3, v20
    v_add_u32 v20, s64, v20
    v_xor_b32 v21, 32, v20
    v_and_b32 v6, 15, v1
    v_lshrrev_b32 v5, 4, v1
    v_lshlrev_b32 v5, 4, v5
    v_add_u32 v5, s68, v5
    v_add_u32 v7, 128, v5
    s_add_u32 s67, s68, 256
    v_mov_b32 v18, s67
    v_cmp_eq_u32 vcc, 0, v6
    s_nop 1
    v_cndmask_b32 v28, v18, v5, vcc
    v_cmp_eq_u32 vcc, 1, v6
    s_nop 1
    v_cndmask_b32 v29, v18, v7, vcc
    s_waitcnt vmcnt(8)
    v_mov_b32 v16, v10
    v_mov_b32 v17, v12
    s_nop 1
    v_max_f32_dpp v16, v16, v16 quad_perm:[1,0,3,2] row_mask:0xf bank_mask:0xf
    v_max_f32_dpp v17, v17, v17 quad_perm:[1,0,3,2] row_mask:0xf bank_mask:0xf
    s_nop 0
    v_max_f32_dpp v16, v16, v16 quad_perm:[2,3,0,1] row_mask:0xf bank_mask:0xf
    v_max_f32_dpp v17, v17, v17 quad_perm:[2,3,0,1] row_mask:0xf bank_mask:0xf
    s_nop 0
    v_max_f32_dpp v16, v16, v16 row_half_mirror row_mask:0xf bank_mask:0xf
    v_max_f32_dpp v17, v17, v17 row_half_mirror row_mask:0xf bank_mask:0xf
    s_nop 0
    v_max_f32_dpp v16, v16, v16 row_mirror row_mask:0xf bank_mask:0xf
    v_max_f32_dpp v17, v17, v17 row_mirror row_mask:0xf bank_mask:0xf
    s_nop 0
    v_mov_b32 v18, v16
    v_mov_b32 v19, v17
    s_nop 1
    v_permlane16_swap_b32 v16, v18
    v_permlane16_swap_b32 v17, v19
    s_nop 0
    v_max_f32 v16, v16, v18
    v_max_f32 v17, v17, v19
    s_nop 0
    v_mov_b32 v18, v16
    v_mov_b32 v19, v17
    s_nop 1
    v_permlane32_swap_b32 v16, v18
    v_permlane32_swap_b32 v17, v19
    s_nop 0
    v_max_f32 v16, v16, v18
    v_max_f32 v17, v17, v19
    s_nop 0
    v_sub_f32 v14, v10, v16
    v_sub_f32 v15, v12, v17
    v_exp_f32 v14, v14
    v_exp_f32 v15, v15
    s_nop 0
    v_cvt_pk_bf16_f32 v14, v14, v14
    v_cvt_pk_bf16_f32 v15, v15, v15
    ds_write_b16 v30, v14
    ds_write_b16 v30, v15 offset:128
    v_lshlrev_b32 v14, 16, v14
    v_lshlrev_b32 v15, 16, v15
    v_mul_f32 v16, v14, v11
    v_mul_f32 v17, v15, v13
    s_nop 1
    v_add_f32_dpp v16, v16, v16 quad_perm:[1,0,3,2] row_mask:0xf bank_mask:0xf
    v_add_f32_dpp v17, v17, v17 quad_perm:[1,0,3,2] row_mask:0xf bank_mask:0xf
    s_nop 0
    v_add_f32_dpp v16, v16, v16 quad_perm:[2,3,0,1] row_mask:0xf bank_mask:0xf
    v_add_f32_dpp v17, v17, v17 quad_perm:[2,3,0,1] row_mask:0xf bank_mask:0xf
    s_nop 0
    v_add_f32_dpp v16, v16, v16 row_half_mirror row_mask:0xf bank_mask:0xf
    v_add_f32_dpp v17, v17, v17 row_half_mirror row_mask:0xf bank_mask:0xf
    s_nop 0
    v_add_f32_dpp v16, v16, v16 row_mirror row_mask:0xf bank_mask:0xf
    v_add_f32_dpp v17, v17, v17 row_mirror row_mask:0xf bank_mask:0xf
    s_nop 0
    v_mov_b32 v18, v16
    v_mov_b32 v19, v17
    s_nop 1
    v_permlane16_swap_b32 v16, v18
    v_permlane16_swap_b32 v17, v19
    s_nop 0
    v_add_f32 v16, v16, v18
    v_add_f32 v17, v17, v19
    s_nop 0
    v_mov_b32 v18, v16
    v_mov_b32 v19, v17
    s_nop 1
    v_permlane32_swap_b32 v16, v18
    v_permlane32_swap_b32 v17, v19
    s_nop 0
    v_add_f32 v16, v16, v18
    v_add_f32 v17, v17, v19
    s_nop 0
    v_rcp_f32 v16, v16
    v_rcp_f32 v17, v17
    v_cmp_eq_u32 vcc, 0, v6
    s_nop 1
    v_cndmask_b32 v16, v17, v16, vcc
    s_waitcnt lgkmcnt(0)
    ds_read_b128 v[32:35], v28 offset:0
    ds_read_b128 v[36:39], v28 offset:64
    ds_read_b128 v[40:43], v29 offset:0
    ds_read_b128 v[44:47], v29 offset:64
    s_waitcnt vmcnt(7)
    ds_write_b128 v31, v[112:115] offset:0
    s_waitcnt vmcnt(6)
    ds_write_b128 v31, v[116:119] offset:1024
    s_waitcnt vmcnt(5)
    ds_write_b128 v31, v[120:123] offset:2048
    s_waitcnt vmcnt(4)
    ds_write_b128 v31, v[124:127] offset:3072
    s_waitcnt lgkmcnt(0)
    ds_read_b64_tr_b16 v[64:65], v20 offset:0
    ds_read_b64_tr_b16 v[66:67], v20 offset:256
    ds_read_b64_tr_b16 v[68:69], v21 offset:0
    ds_read_b64_tr_b16 v[70:71], v21 offset:256
    ds_read_b64_tr_b16 v[72:73], v20 offset:2048
    ds_read_b64_tr_b16 v[74:75], v20 offset:2304
    ds_read_b64_tr_b16 v[76:77], v21 offset:2048
    ds_read_b64_tr_b16 v[78:79], v21 offset:2304
    s_waitcnt lgkmcnt(0)
    v_mfma_f32_16x16x32_bf16 v[48:51], v[64:67], v[32:35], 0
    v_mfma_f32_16x16x32_bf16 v[52:55], v[68:71], v[32:35], 0
    v_mfma_f32_16x16x32_bf16 v[48:51], v[72:75], v[36:39], v[48:51]
    v_mfma_f32_16x16x32_bf16 v[52:55], v[76:79], v[36:39], v[52:55]
    s_waitcnt vmcnt(3)
    ds_write_b128 v31, v[128:131] offset:0
    s_waitcnt vmcnt(2)
    ds_write_b128 v31, v[132:135] offset:1024
    s_waitcnt vmcnt(1)
    ds_write_b128 v31, v[136:139] offset:2048
    s_waitcnt vmcnt(0)
    ds_write_b128 v31, v[140:143] offset:3072
    s_waitcnt lgkmcnt(0)
    ds_read_b64_tr_b16 v[64:65], v20 offset:0
    ds_read_b64_tr_b16 v[66:67], v20 offset:256
    ds_read_b64_tr_b16 v[68:69], v21 offset:0
    ds_read_b64_tr_b16 v[70:71], v21 offset:256
    ds_read_b64_tr_b16 v[72:73], v20 offset:2048
    ds_read_b64_tr_b16 v[74:75], v20 offset:2304
    ds_read_b64_tr_b16 v[76:77], v21 offset:2048
    ds_read_b64_tr_b16 v[78:79], v21 offset:2304
    s_waitcnt lgkmcnt(0)
    v_mfma_f32_16x16x32_bf16 v[48:51], v[64:67], v[40:43], v[48:51]
    v_mfma_f32_16x16x32_bf16 v[52:55], v[68:71], v[40:43], v[52:55]
    v_mfma_f32_16x16x32_bf16 v[48:51], v[72:75], v[44:47], v[48:51]
    v_mfma_f32_16x16x32_bf16 v[52:55], v[76:79], v[44:47], v[52:55]
    v_lshrrev_b32 v5, 4, v1
    v_lshlrev_b32 v7, 8, v6
    v_lshl_add_u32 v7, v5, 3, v7
    s_lshl_b32 s67, s52, 6
    s_add_u32 s67, s67, 149504
    v_add_u32 v31, s67, v7
    v_cmp_gt_u32 vcc, 2, v6
    s_and_saveexec_b64 s[72:73], vcc
    s_nop 2
    v_mul_f32 v48, v48, v16
    v_mul_f32 v49, v49, v16
    v_mul_f32 v50, v50, v16
    v_mul_f32 v51, v51, v16
    v_cvt_pk_bf16_f32 v48, v48, v49
    v_cvt_pk_bf16_f32 v49, v50, v51
    ds_write_b64 v31, v[48:49] offset:0
    v_mul_f32 v52, v52, v16
    v_mul_f32 v53, v53, v16
    v_mul_f32 v54, v54, v16
    v_mul_f32 v55, v55, v16
    v_cvt_pk_bf16_f32 v52, v52, v53
    v_cvt_pk_bf16_f32 v53, v54, v55
    ds_write_b64 v31, v[52:53] offset:32
    s_mov_b64 exec, s[72:73]
    v_and_b32 v28, 1, v1
    v_mul_u32_u24 v28, 256, v28
    v_lshrrev_b32 v5, 4, v1
    v_lshl_add_u32 v28, v5, 4, v28
    v_add_u32 v28, 149504, v28
    s_waitcnt lgkmcnt(0)
    s_barrier
    ds_read_b128 v[32:35], v28 offset:0
    ds_read_b128 v[36:39], v28 offset:64
    ds_read_b128 v[40:43], v28 offset:128
    ds_read_b128 v[44:47], v28 offset:192
    s_waitcnt lgkmcnt(0)
    v_mfma_f32_16x16x32_bf16 v[48:51], a[128:131], v[32:35], 0
    v_mfma_f32_16x16x32_bf16 v[52:55], a[132:135], v[32:35], 0
    v_mfma_f32_16x16x32_bf16 v[48:51], a[136:139], v[36:39], v[48:51]
    v_mfma_f32_16x16x32_bf16 v[52:55], a[140:143], v[36:39], v[52:55]
    v_mfma_f32_16x16x32_bf16 v[48:51], a[144:147], v[40:43], v[48:51]
    v_mfma_f32_16x16x32_bf16 v[52:55], a[148:151], v[40:43], v[52:55]
    v_mfma_f32_16x16x32_bf16 v[48:51], a[152:155], v[44:47], v[48:51]
    v_mfma_f32_16x16x32_bf16 v[52:55], a[156:159], v[44:47], v[52:55]
    s_and_saveexec_b64 s[72:73], vcc
    s_nop 6
    v_cvt_pk_bf16_f32 v48, v48, v49
    v_cvt_pk_bf16_f32 v49, v50, v51
    ds_write_b64 v31, v[48:49] offset:512
    v_cvt_pk_bf16_f32 v52, v52, v53
    v_cvt_pk_bf16_f32 v53, v54, v55
    ds_write_b64 v31, v[52:53] offset:544
    s_mov_b64 exec, s[72:73]
    s_waitcnt lgkmcnt(0)
    s_barrier
    ds_read_b128 v[32:35], v28 offset:512
    ds_read_b128 v[36:39], v28 offset:576
    ds_read_b128 v[40:43], v28 offset:640
    ds_read_b128 v[44:47], v28 offset:704
    s_waitcnt lgkmcnt(0)
    v_mfma_f32_16x16x32_bf16 v[48:51], a[160:163], v[32:35], 0
    v_mfma_f32_16x16x32_bf16 v[52:55], a[164:167], v[32:35], 0
    v_mfma_f32_16x16x32_bf16 v[56:59], a[168:171], v[32:35], 0
    v_mfma_f32_16x16x32_bf16 v[60:63], a[172:175], v[32:35], 0
    v_mfma_f32_16x16x32_bf16 v[48:51], a[176:179], v[36:39], v[48:51]
    v_mfma_f32_16x16x32_bf16 v[52:55], a[180:183], v[36:39], v[52:55]
    v_mfma_f32_16x16x32_bf16 v[56:59], a[184:187], v[36:39], v[56:59]
    v_mfma_f32_16x16x32_bf16 v[60:63], a[188:191], v[36:39], v[60:63]
    v_mfma_f32_16x16x32_bf16 v[48:51], a[192:195], v[40:43], v[48:51]
    v_mfma_f32_16x16x32_bf16 v[52:55], a[196:199], v[40:43], v[52:55]
    v_mfma_f32_16x16x32_bf16 v[56:59], a[200:203], v[40:43], v[56:59]
    v_mfma_f32_16x16x32_bf16 v[60:63], a[204:207], v[40:43], v[60:63]
    v_mfma_f32_16x16x32_bf16 v[48:51], a[208:211], v[44:47], v[48:51]
    v_mfma_f32_16x16x32_bf16 v[52:55], a[212:215], v[44:47], v[52:55]
    v_mfma_f32_16x16x32_bf16 v[56:59], a[216:219], v[44:47], v[56:59]
    v_mfma_f32_16x16x32_bf16 v[60:63], a[220:223], v[44:47], v[60:63]
    s_lshl_b32 s67, s52, 9
    s_add_u32 s67, s67, 150528
    s_lshl_b32 s68, s58, 1
    s_and_b32 s69, s56, 1
    s_add_u32 s68, s68, s69
    s_and_b32 s68, s68, 7
    s_lshl_b32 s68, s68, 12
    s_lshl_b32 s69, s59, 10
    s_add_u32 s68, s68, s69
    s_lshl_b32 s69, s52, 8
    s_add_u32 s68, s68, s69
    s_add_u32 s68, s68, 0x20000
    s_add_u32 s68, s68, s55
    v_and_b32 v6, 15, v1
    v_lshrrev_b32 v5, 4, v1
    v_mul_u32_u24 v14, 256, v6
    v_lshl_add_u32 v14, v5, 4, v14
    v_add_u32 v14, s67, v14
    v_cmp_gt_u32 vcc, 2, v6
    s_and_saveexec_b64 s[72:73], vcc
    s_nop 4
    ds_write_b128 v14, v[48:51] offset:0
    ds_write_b128 v14, v[52:55] offset:64
    ds_write_b128 v14, v[56:59] offset:128
    ds_write_b128 v14, v[60:63] offset:192
    s_mov_b64 exec, s[72:73]
    v_lshlrev_b32 v5, 2, v1
    v_add_u32 v14, s67, v5
    s_waitcnt lgkmcnt(0)
    ds_read_b32 v15, v14 offset:0
    ds_read_b32 v16, v14 offset:256
    s_waitcnt lgkmcnt(1)
    buffer_atomic_add_f32 v15, v5, s[48:51], s68 offen offset:0
    s_waitcnt lgkmcnt(0)
    buffer_atomic_add_f32 v16, v5, s[48:51], s68 offen offset:2048
    s_waitcnt vmcnt(0)
    s_barrier
    s_cmp_lg_u32 s52, 0
    s_cbranch_scc1 L_pub35
    v_lshlrev_b32 v6, 12, v1
    s_mov_b64 s[72:73], exec
    s_mov_b64 exec, 1
    s_mov_b64 exec, 0xff
    s_lshl_b32 s62, s54, 17
    s_and_b32 s63, s2, 15
    s_lshl_b32 s63, s63, 8
    s_add_u32 s62, s62, s63
    s_add_u32 s62, s62, 0x1210000
    v_mov_b32 v5, 1
    buffer_atomic_add v5, v6, s[48:51], s62 offen sc1
    s_mov_b64 exec, s[72:73]
L_pub35:
    s_cmp_eq_u32 s61, 0
    s_cbranch_scc1 L_nod37
    s_cmp_lg_u32 s52, 0
    s_cbranch_scc1 L_wf39
    s_mov_b32 s63, 400000
    s_sub_u32 s62, s54, 0
    s_lshl_b32 s62, s62, 17
    s_add_u32 s62, s62, 0x1210000
    s_and_b32 s64, s2, 7
    s_lshl_b32 s64, s64, 12
    s_add_u32 s62, s62, s64
    v_and_b32 v5, 15, v1
    v_mov_b32 v6, 16
    v_lshlrev_b32 v5, 8, v5
L_poll40:
    buffer_load_dword v196, v5, s[48:51], s62 offen sc0 sc1
    s_waitcnt vmcnt(0)
    v_cmp_ne_u32 vcc, v6, v196
    s_cbranch_vccz L_pdone41
    s_sub_u32 s63, s63, 1
    s_cmp_lg_u32 s63, 0
    s_cbranch_scc1 L_poll40
L_pdone41:
L_wf39:
    s_barrier
    s_cmp_eq_u32 s54, 0
    s_cbranch_scc1 L_d_l044
    s_sub_u32 s62, s55, 0x800000
    s_add_u32 s62, s62, 0x39000
    buffer_load_dwordx2 v[8:9], v2, s[48:51], s62 offen sc0 sc1
    s_branch L_d_j45
L_d_l044:
    buffer_load_dwordx2 v[8:9], v2, s[8:11], 0 offen
L_d_j45:
    s_add_u32 s63, s55, 0x20000
    buffer_load_dwordx4 v[28:31], v3, s[48:51], s63 offen sc0 sc1
    s_add_u32 s63, s55, 0x21000
    buffer_load_dwordx4 v[32:35], v3, s[48:51], s63 offen sc0 sc1
    s_add_u32 s63, s55, 0x22000
    buffer_load_dwordx4 v[36:39], v3, s[48:51], s63 offen sc0 sc1
    s_add_u32 s63, s55, 0x23000
    buffer_load_dwordx4 v[40:43], v3, s[48:51], s63 offen sc0 sc1
    s_add_u32 s63, s55, 0x24000
    buffer_load_dwordx4 v[44:47], v3, s[48:51], s63 offen sc0 sc1
    s_add_u32 s63, s55, 0x25000
    buffer_load_dwordx4 v[48:51], v3, s[48:51], s63 offen sc0 sc1
    s_add_u32 s63, s55, 0x26000
    buffer_load_dwordx4 v[52:55], v3, s[48:51], s63 offen sc0 sc1
    s_add_u32 s63, s55, 0x27000
    buffer_load_dwordx4 v[56:59], v3, s[48:51], s63 offen sc0 sc1
    s_add_u32 s67, s55, 0x38000
    s_waitcnt vmcnt(0)
    v_lshlrev_b32 v12, 16, v8
    v_and_b32 v13, 0xffff0000, v8
    v_lshlrev_b32 v14, 16, v9
    v_and_b32 v15, 0xffff0000, v9
    v_pk_add_f32 v[28:29], v[28:29], v[44:45]
    v_pk_add_f32 v[30:31], v[30:31], v[46:47]
    v_pk_add_f32 v[32:33], v[32:33], v[48:49]
    v_pk_add_f32 v[34:35], v[34:35], v[50:51]
    v_pk_add_f32 v[36:37], v[36:37], v[52:53]
    v_pk_add_f32 v[38:39], v[38:39], v[54:55]
    v_pk_add_f32 v[40:41], v[40:41], v[56:57]
    v_pk_add_f32 v[42:43], v[42:43], v[58:59]
    v_pk_add_f32 v[28:29], v[28:29], v[36:37]
    v_pk_add_f32 v[30:31], v[30:31], v[38:39]
    v_pk_add_f32 v[32:33], v[32:33], v[40:41]
    v_pk_add_f32 v[34:35], v[34:35], v[42:43]
    v_pk_add_f32 v[28:29], v[28:29], v[32:33]
    v_pk_add_f32 v[30:31], v[30:31], v[34:35]
    v_cvt_pk_bf16_f32 v18, v28, v29
    v_cvt_pk_bf16_f32 v19, v30, v31
    v_lshlrev_b32 v28, 16, v18
    v_and_b32 v29, 0xffff0000, v18
    v_lshlrev_b32 v30, 16, v19
    v_and_b32 v31, 0xffff0000, v19
    v_pk_add_f32 v[12:13], v[12:13], v[28:29]
    v_pk_add_f32 v[14:15], v[14:15], v[30:31]
    v_cvt_pk_bf16_f32 v8, v12, v13
    v_cvt_pk_bf16_f32 v9, v14, v15
    v_lshlrev_b32 v12, 16, v8
    v_and_b32 v13, 0xffff0000, v8
    v_lshlrev_b32 v14, 16, v9
    v_and_b32 v15, 0xffff0000, v9
    s_cmp_lg_u32 s2, 128
    s_cbranch_scc1 L_nox46
    buffer_store_dwordx2 v[8:9], v2, s[48:51], s67 offen sc0 sc1
L_nox46:
    v_add_f32 v16, v12, v13
    v_add_f32 v18, v14, v15
    v_mul_f32 v17, v12, v12
    v_mul_f32 v19, v14, v14
    v_fmac_f32 v17, v13, v13
    v_fmac_f32 v19, v15, v15
    v_add_f32 v16, v16, v18
    v_add_f32 v17, v17, v19
    s_nop 1
    v_add_f32_dpp v16, v16, v16 quad_perm:[1,0,3,2] row_mask:0xf bank_mask:0xf
    v_add_f32_dpp v17, v17, v17 quad_perm:[1,0,3,2] row_mask:0xf bank_mask:0xf
    s_nop 0
    v_add_f32_dpp v16, v16, v16 quad_perm:[2,3,0,1] row_mask:0xf bank_mask:0xf
    v_add_f32_dpp v17, v17, v17 quad_perm:[2,3,0,1] row_mask:0xf bank_mask:0xf
    s_nop 0
    v_add_f32_dpp v16, v16, v16 row_half_mirror row_mask:0xf bank_mask:0xf
    v_add_f32_dpp v17, v17, v17 row_half_mirror row_mask:0xf bank_mask:0xf
    s_nop 0
    v_add_f32_dpp v16, v16, v16 row_mirror row_mask:0xf bank_mask:0xf
    v_add_f32_dpp v17, v17, v17 row_mirror row_mask:0xf bank_mask:0xf
    s_nop 0
    v_mov_b32 v18, v16
    v_mov_b32 v19, v17
    s_nop 1
    v_permlane16_swap_b32 v16, v18
    v_permlane16_swap_b32 v17, v19
    s_nop 0
    v_add_f32 v16, v16, v18
    v_add_f32 v17, v17, v19
    s_nop 0
    v_mov_b32 v18, v16
    v_mov_b32 v19, v17
    s_nop 1
    v_permlane32_swap_b32 v16, v18
    v_permlane32_swap_b32 v17, v19
    s_nop 0
    v_add_f32 v16, v16, v18
    v_add_f32 v17, v17, v19
    s_nop 0
    s_lshl_b32 s62, s52, 3
    s_add_u32 s62, s62, 138240
    v_mov_b32 v18, s62
    s_and_b32 s63, s52, 2
    s_lshl_b32 s63, s63, 3
    s_add_u32 s63, s63, 138240
    v_mov_b32 v19, s63
    ds_write_b64 v18, v[16:17]
    s_waitcnt lgkmcnt(0)
    s_barrier
    ds_read_b128 v[20:23], v19
    s_waitcnt lgkmcnt(0)
    v_add_f32 v16, v20, v22
    v_add_f32 v17, v21, v23
    v_mul_f32 v16, 0x3b000000, v16
    v_mul_f32 v17, 0x3b000000, v17
    v_fma_f32 v17, -v16, v16, v17
    v_max_f32 v17, 0, v17
    v_cvt_pk_bf16_f32 v17, v17, v17
    v_lshlrev_b32 v17, 16, v17
    v_add_f32 v17, 0x3727c5ac, v17
    v_cvt_pk_bf16_f32 v17, v17, v17
    v_lshlrev_b32 v17, 16, v17
    v_sqrt_f32 v17, v17
    v_cvt_pk_bf16_f32 v16, v16, v16
    v_lshlrev_b32 v16, 16, v16
    v_cvt_pk_bf16_f32 v17, v17, v17
    v_lshlrev_b32 v17, 16, v17
    v_rcp_f32 v17, v17
    v_sub_f32 v12, v12, v16
    v_sub_f32 v13, v13, v16
    v_sub_f32 v14, v14, v16
    v_sub_f32 v15, v15, v16
    v_cvt_pk_bf16_f32 v18, v12, v13
    v_cvt_pk_bf16_f32 v19, v14, v15
    v_lshlrev_b32 v12, 16, v18
    v_and_b32 v13, 0xffff0000, v18
    v_lshlrev_b32 v14, 16, v19
    v_and_b32 v15, 0xffff0000, v19
    v_mul_f32 v12, v12, v17
    v_mul_f32 v13, v13, v17
    v_mul_f32 v14, v14, v17
    v_mul_f32 v15, v15, v17
    v_cvt_pk_bf16_f32 v20, v12, v13
    v_cvt_pk_bf16_f32 v21, v14, v15
    v_add_u32 v18, 131072, v2
    ds_write_b64 v18, v[20:21]
    s_waitcnt lgkmcnt(0)
    s_barrier
    s_lshl_b32 s62, s52, 8
    v_and_b32 v12, 1, v1
    v_mul_u32_u24 v12, 1024, v12
    v_lshrrev_b32 v5, 4, v1
    v_lshl_add_u32 v12, v5, 4, v12
    v_add_u32 v12, 131072, v12
    v_add_u32 v12, s62, v12
    ds_read_b128 v[60:63], v12 offset:0
    ds_read_b128 v[64:67], v12 offset:64
    ds_read_b128 v[68:71], v12 offset:128
    ds_read_b128 v[72:75], v12 offset:192
    s_waitcnt lgkmcnt(0)
    v_mfma_f32_16x16x32_bf16 v[120:123], a[224:227], v[60:63], 0
    v_mfma_f32_16x16x32_bf16 v[120:123], a[228:231], v[64:67], v[120:123]
    v_mfma_f32_16x16x32_bf16 v[120:123], a[232:235], v[68:71], v[120:123]
    v_mfma_f32_16x16x32_bf16 v[120:123], a[236:239], v[72:75], v[120:123]
    v_mfma_f32_16x16x32_bf16 v[124:127], a[240:243], v[60:63], 0
    v_mfma_f32_16x16x32_bf16 v[124:127], a[244:247], v[64:67], v[124:127]
    v_mfma_f32_16x16x32_bf16 v[124:127], a[248:251], v[68:71], v[124:127]
    v_mfma_f32_16x16x32_bf16 v[124:127], a[252:255], v[72:75], v[124:127]
    v_and_b32 v6, 15, v1
    v_lshrrev_b32 v5, 4, v1
    v_lshlrev_b32 v12, 6, v6
    v_lshl_add_u32 v12, v5, 4, v12
    s_lshl_b32 s62, s52, 8
    s_add_u32 s62, s62, 133120
    v_add_u32 v12, s62, v12
    v_cmp_gt_u32 vcc, 2, v6
    s_and_saveexec_b64 s[72:73], vcc
    s_nop 2
    ds_write_b128 v12, v[120:123]
    ds_write_b128 v12, v[124:127] offset:128
    s_mov_b64 exec, s[72:73]
    v_and_b32 v12, 1, v1
    v_mul_u32_u24 v12, 64, v12
    v_lshrrev_b32 v5, 4, v1
    v_lshl_add_u32 v12, v5, 4, v12
    v_add_u32 v12, 133120, v12
    s_waitcnt lgkmcnt(0)
    s_barrier
    ds_read_b128 v[88:91], v12 offset:0
    ds_read_b128 v[104:107], v12 offset:128
    ds_read_b128 v[92:95], v12 offset:256
    ds_read_b128 v[108:111], v12 offset:384
    ds_read_b128 v[96:99], v12 offset:512
    ds_read_b128 v[112:115], v12 offset:640
    ds_read_b128 v[100:103], v12 offset:768
    ds_read_b128 v[116:119], v12 offset:896
    s_waitcnt lgkmcnt(0)
    v_add_f32 v88, v88, v92
    v_add_f32 v96, v96, v100
    v_add_f32 v88, v88, v96
    v_add_f32 v89, v89, v93
    v_add_f32 v97, v97, v101
    v_add_f32 v89, v89, v97
    v_add_f32 v90, v90, v94
    v_add_f32 v98, v98, v102
    v_add_f32 v90, v90, v98
    v_add_f32 v91, v91, v95
    v_add_f32 v99, v99, v103
    v_add_f32 v91, v91, v99
    v_cvt_pk_bf16_f32 v92, v88, v89
    v_lshlrev_b32 v88, 16, v92
    v_and_b32 v89, 0xffff0000, v92
    v_cvt_pk_bf16_f32 v92, v90, v91
    v_lshlrev_b32 v90, 16, v92
    v_and_b32 v91, 0xffff0000, v92
    v_add_f32 v104, v104, v108
    v_add_f32 v112, v112, v116
    v_add_f32 v104, v104, v112
    v_add_f32 v105, v105, v109
    v_add_f32 v113, v113, v117
    v_add_f32 v105, v105, v113
    v_add_f32 v106, v106, v110
    v_add_f32 v114, v114, v118
    v_add_f32 v106, v106, v114
    v_add_f32 v107, v107, v111
    v_add_f32 v115, v115, v119
    v_add_f32 v107, v107, v115
    v_cvt_pk_bf16_f32 v108, v104, v105
    v_lshlrev_b32 v104, 16, v108
    v_and_b32 v105, 0xffff0000, v108
    v_cvt_pk_bf16_f32 v108, v106, v107
    v_lshlrev_b32 v106, 16, v108
    v_and_b32 v107, 0xffff0000, v108
    v_mul_f32 v92, 0xbfb8aa3b, v88
    v_mul_f32 v93, 0xbfb8aa3b, v89
    v_mul_f32 v94, 0xbfb8aa3b, v90
    v_mul_f32 v95, 0xbfb8aa3b, v91
    v_exp_f32 v92, v92
    v_exp_f32 v93, v93
    v_exp_f32 v94, v94
    v_exp_f32 v95, v95
    s_nop 0
    v_add_f32 v92, 1.0, v92
    v_add_f32 v93, 1.0, v93
    v_add_f32 v94, 1.0, v94
    v_add_f32 v95, 1.0, v95
    v_rcp_f32 v92, v92
    v_rcp_f32 v93, v93
    v_rcp_f32 v94, v94
    v_rcp_f32 v95, v95
    s_nop 0
    v_mul_f32 v92, v92, v88
    v_mul_f32 v93, v93, v89
    v_mul_f32 v94, v94, v90
    v_mul_f32 v95, v95, v91
    v_cvt_pk_bf16_f32 v96, v92, v93
    v_lshlrev_b32 v92, 16, v96
    v_and_b32 v93, 0xffff0000, v96
    v_cvt_pk_bf16_f32 v96, v94, v95
    v_lshlrev_b32 v94, 16, v96
    v_and_b32 v95, 0xffff0000, v96
    v_mul_f32 v92, v92, v104
    v_mul_f32 v93, v93, v105
    v_mul_f32 v94, v94, v106
    v_mul_f32 v95, v95, v107
    v_cvt_pk_bf16_f32 v120, v92, v93
    v_cvt_pk_bf16_f32 v121, v94, v95
    s_waitcnt lgkmcnt(0)
    s_nop 0
    v_mfma_f32_16x16x16_bf16 v[144:147], v[240:241], v[120:121], 0
    v_mfma_f32_16x16x16_bf16 v[148:151], v[242:243], v[120:121], 0
    v_mfma_f32_16x16x16_bf16 v[152:155], v[244:245], v[120:121], 0
    v_mfma_f32_16x16x16_bf16 v[156:159], v[246:247], v[120:121], 0
    v_mfma_f32_16x16x16_bf16 v[160:163], v[248:249], v[120:121], 0
    v_mfma_f32_16x16x16_bf16 v[164:167], v[250:251], v[120:121], 0
    v_mfma_f32_16x16x16_bf16 v[168:171], v[252:253], v[120:121], 0
    v_mfma_f32_16x16x16_bf16 v[172:175], v[254:255], v[120:121], 0
    s_lshl_b32 s67, s52, 10
    s_add_u32 s67, s67, 134144
    s_and_b32 s68, s2, 7
    s_lshl_b32 s68, s68, 12
    s_lshl_b32 s69, s52, 9
    s_add_u32 s68, s68, s69
    s_add_u32 s68, s68, 0x28000
    s_add_u32 s68, s68, s55
    v_and_b32 v6, 15, v1
    v_lshrrev_b32 v5, 4, v1
    v_mul_u32_u24 v12, 512, v6
    v_lshl_add_u32 v12, v5, 4, v12
    v_add_u32 v12, s67, v12
    v_cmp_gt_u32 vcc, 2, v6
    s_and_saveexec_b64 s[72:73], vcc
    s_nop 4
    ds_write_b128 v12, v[144:147] offset:0
    ds_write_b128 v12, v[148:151] offset:64
    ds_write_b128 v12, v[152:155] offset:128
    ds_write_b128 v12, v[156:159] offset:192
    ds_write_b128 v12, v[160:163] offset:256
    ds_write_b128 v12, v[164:167] offset:320
    ds_write_b128 v12, v[168:171] offset:384
    ds_write_b128 v12, v[172:175] offset:448
    s_mov_b64 exec, s[72:73]
    v_lshlrev_b32 v5, 2, v1
    v_add_u32 v12, s67, v5
    s_waitcnt lgkmcnt(0)
    ds_read_b32 v13, v12 offset:0
    ds_read_b32 v14, v12 offset:256
    ds_read_b32 v15, v12 offset:512
    ds_read_b32 v16, v12 offset:768
    s_waitcnt lgkmcnt(3)
    buffer_atomic_add_f32 v13, v5, s[48:51], s68 offen offset:0
    s_waitcnt lgkmcnt(2)
    buffer_atomic_add_f32 v14, v5, s[48:51], s68 offen offset:256
    s_waitcnt lgkmcnt(1)
    buffer_atomic_add_f32 v15, v5, s[48:51], s68 offen offset:2048
    s_waitcnt lgkmcnt(0)
    buffer_atomic_add_f32 v16, v5, s[48:51], s68 offen offset:2304
    s_waitcnt vmcnt(0)
    s_barrier
    s_cmp_lg_u32 s52, 0
    s_cbranch_scc1 L_pub47
    v_lshlrev_b32 v6, 12, v1
    s_mov_b64 s[72:73], exec
    s_mov_b64 exec, 1
    s_mov_b64 exec, 0xff
    s_lshl_b32 s62, s54, 17
    s_and_b32 s63, s2, 15
    s_lshl_b32 s63, s63, 8
    s_add_u32 s62, s62, s63
    s_add_u32 s62, s62, 0x1218000
    v_mov_b32 v5, 1
    buffer_atomic_add v5, v6, s[48:51], s62 offen sc1
    s_mov_b64 exec, s[72:73]
L_pub47:
L_nod37:
    s_cmp_eq_u32 s54, 1
    s_cbranch_scc1 L_fin38
    s_mov_b32 s54, 1
    s_mov_b32 s55, 0x800000
    s_cmp_lg_u32 s52, 0
    s_cbranch_scc1 L_wf49
    s_mov_b32 s63, 400000
    s_sub_u32 s62, s54, 1
    s_lshl_b32 s62, s62, 17
    s_add_u32 s62, s62, 0x1218000
    s_and_b32 s64, s2, 7
    s_lshl_b32 s64, s64, 12
    s_add_u32 s62, s62, s64
    v_and_b32 v5, 15, v1
    v_and_b32 v6, 4, v1
    v_cmp_eq_u32 vcc, 0, v6
    v_mov_b32 v6, 6
    v_mov_b32 v7, 8
    v_cndmask_b32 v6, v6, v7, vcc
    v_lshlrev_b32 v5, 8, v5
L_poll50:
    buffer_load_dword v196, v5, s[48:51], s62 offen sc0 sc1
    s_waitcnt vmcnt(0)
    v_cmp_ne_u32 vcc, v6, v196
    s_cbranch_vccz L_pdone51
    s_sub_u32 s63, s63, 1
    s_cmp_lg_u32 s63, 0
    s_cbranch_scc1 L_poll50
L_pdone51:
L_wf49:
    s_barrier
    s_branch L_layer
L_fin38:
    s_cmp_lg_u32 s2, 128
    s_cbranch_scc1 L_end
    s_cmp_lg_u32 s52, 0
    s_cbranch_scc1 L_wf54
    s_mov_b32 s63, 400000
    s_sub_u32 s62, s54, 0
    s_lshl_b32 s62, s62, 17
    s_add_u32 s62, s62, 0x1218000
    s_and_b32 s64, s2, 7
    s_lshl_b32 s64, s64, 12
    s_add_u32 s62, s62, s64
    v_and_b32 v5, 15, v1
    v_and_b32 v6, 4, v1
    v_cmp_eq_u32 vcc, 0, v6
    v_mov_b32 v6, 6
    v_mov_b32 v7, 8
    v_cndmask_b32 v6, v6, v7, vcc
    v_lshlrev_b32 v5, 8, v5
L_poll55:
    buffer_load_dword v196, v5, s[48:51], s62 offen sc0 sc1
    s_waitcnt vmcnt(0)
    v_cmp_ne_u32 vcc, v6, v196
    s_cbranch_vccz L_pdone56
    s_sub_u32 s63, s63, 1
    s_cmp_lg_u32 s63, 0
    s_cbranch_scc1 L_poll55
L_pdone56:
L_wf54:
    s_barrier
    s_add_u32 s63, s55, 0x38000
    buffer_load_dwordx2 v[8:9], v2, s[48:51], s63 offen sc0 sc1
    s_add_u32 s63, s55, 0x28000
    buffer_load_dwordx4 v[28:31], v3, s[48:51], s63 offen sc0 sc1
    s_add_u32 s63, s55, 0x29000
    buffer_load_dwordx4 v[32:35], v3, s[48:51], s63 offen sc0 sc1
    s_add_u32 s63, s55, 0x2a000
    buffer_load_dwordx4 v[36:39], v3, s[48:51], s63 offen sc0 sc1
    s_add_u32 s63, s55, 0x2b000
    buffer_load_dwordx4 v[40:43], v3, s[48:51], s63 offen sc0 sc1
    s_add_u32 s63, s55, 0x2c000
    buffer_load_dwordx4 v[44:47], v3, s[48:51], s63 offen sc0 sc1
    s_add_u32 s63, s55, 0x2d000
    buffer_load_dwordx4 v[48:51], v3, s[48:51], s63 offen sc0 sc1
    s_add_u32 s63, s55, 0x2e000
    buffer_load_dwordx4 v[52:55], v3, s[48:51], s63 offen sc0 sc1
    s_add_u32 s63, s55, 0x2f000
    buffer_load_dwordx4 v[56:59], v3, s[48:51], s63 offen sc0 sc1
    s_waitcnt vmcnt(0)
    v_lshlrev_b32 v12, 16, v8
    v_and_b32 v13, 0xffff0000, v8
    v_lshlrev_b32 v14, 16, v9
    v_and_b32 v15, 0xffff0000, v9
    v_pk_add_f32 v[28:29], v[28:29], v[44:45]
    v_pk_add_f32 v[30:31], v[30:31], v[46:47]
    v_pk_add_f32 v[32:33], v[32:33], v[48:49]
    v_pk_add_f32 v[34:35], v[34:35], v[50:51]
    v_pk_add_f32 v[36:37], v[36:37], v[52:53]
    v_pk_add_f32 v[38:39], v[38:39], v[54:55]
    v_pk_add_f32 v[40:41], v[40:41], v[56:57]
    v_pk_add_f32 v[42:43], v[42:43], v[58:59]
    v_pk_add_f32 v[28:29], v[28:29], v[36:37]
    v_pk_add_f32 v[30:31], v[30:31], v[38:39]
    v_pk_add_f32 v[32:33], v[32:33], v[40:41]
    v_pk_add_f32 v[34:35], v[34:35], v[42:43]
    v_pk_add_f32 v[28:29], v[28:29], v[32:33]
    v_pk_add_f32 v[30:31], v[30:31], v[34:35]
    v_cvt_pk_bf16_f32 v18, v28, v29
    v_cvt_pk_bf16_f32 v19, v30, v31
    v_lshlrev_b32 v28, 16, v18
    v_and_b32 v29, 0xffff0000, v18
    v_lshlrev_b32 v30, 16, v19
    v_and_b32 v31, 0xffff0000, v19
    v_pk_add_f32 v[12:13], v[12:13], v[28:29]
    v_pk_add_f32 v[14:15], v[14:15], v[30:31]
    v_cvt_pk_bf16_f32 v8, v12, v13
    v_cvt_pk_bf16_f32 v9, v14, v15
    v_lshlrev_b32 v12, 16, v8
    v_and_b32 v13, 0xffff0000, v8
    v_lshlrev_b32 v14, 16, v9
    v_and_b32 v15, 0xffff0000, v9
    buffer_store_dwordx2 v[8:9], v2, s[44:47], 0 offen
    v_mov_b32 v5, s53
    v_mov_b32 v6, 0
    s_mov_b32 s62, 0x1100000
    v_cmp_eq_u32 vcc, 0, v0
    s_and_saveexec_b64 s[72:73], vcc
    buffer_store_dword v5, v6, s[48:51], s62 offen sc0 sc1
    s_mov_b64 exec, s[72:73]
L_end:
    s_endpgm
.section .rodata,"a"
.p2align 6
.amdhsa_kernel interleave_layers__compressed_kv_cla__glu_gated_swiglu__decode_kernel
  .amdhsa_next_free_vgpr 512
  .amdhsa_next_free_sgpr 96
  .amdhsa_accum_offset 256
  .amdhsa_group_segment_fixed_size 0
  .amdhsa_kernarg_size 104
  .amdhsa_user_sgpr_count 2
  .amdhsa_user_sgpr_kernarg_segment_ptr 1
  .amdhsa_system_sgpr_workgroup_id_x 1
.end_amdhsa_kernel
```
